```python
import torch

def _softmax(x, axis=-1):
    return torch.softmax(x, dim=axis)
def _gelu(x):
    return torch.nn.functional.gelu(x, approximate="tanh")
def _silu(x):
    return torch.nn.functional.silu(x)
def _sigmoid(x):
    return torch.sigmoid(x)
def _layernorm(x, axis=-1, eps=1e-5):
    m = x.mean(dim=axis, keepdim=True)
    v = x.var(dim=axis, keepdim=True, unbiased=False)
    return (x - m) / torch.sqrt(v + eps)
def _scatter_add(tgt, idx, src, axis=0):
    return tgt.clone().index_add_(axis, idx, src)
def _segment_sum(src, seg, n):
    out = torch.zeros((n,) + src.shape[1:], dtype=src.dtype)
    return out.index_add_(0, seg, src)
def _pad(x, pw):
    flat = tuple(v for pair in reversed(pw) for v in pair)
    return torch.nn.functional.pad(x, flat)

kernel_name = 'standalone__mixer_token_mlp__prompt'

def setup_inputs():

    _w = (lambda a: (lambda t: t.to(torch.bfloat16) if t.is_floating_point() else t)(torch.as_tensor(a)))
    B, S, D, F = 1, 2048, 512, 1792
    return {
        "x": _w((lambda *s: torch.randn(*s, dtype=torch.bfloat16) * 0.05)(B, S, D)),
        "w1": _w((lambda *s: torch.randn(*s, dtype=torch.bfloat16) * 0.2)(S, F) * (S ** -0.5)),
        "b1": _w((lambda *s: torch.randn(*s, dtype=torch.bfloat16) * 3.2)(F) * 0.02),
        "w2": _w((lambda *s: torch.randn(*s, dtype=torch.bfloat16) * 0.05)(F, S) * (F ** -0.5)),
        "b2": _w((lambda *s: torch.randn(*s, dtype=torch.bfloat16) * 0.1)(S) * 0.02),
    }

def reference(x, w1, b1, w2, b2):
    B, S, D = x.shape
    h = _layernorm(x, axis=-1)
    u = torch.einsum("bsd,sf->bdf", h, w1) + b1
    u = _gelu(u)
    y = torch.einsum("bdf,fs->bds", u, w2) + b2
    return (lambda x, *d: x.permute(*d))(y, 0, 2, 1)
```

```asm
; @launch grid=(256,1,1) block=(256,1,1) lds=163840
.amdgcn_target "amdgcn-amd-amdhsa--gfx950"
.text
.globl standalone__mixer_token_mlp__prompt_kernel
.p2align 8
.type standalone__mixer_token_mlp__prompt_kernel,@function
standalone__mixer_token_mlp__prompt_kernel:
    s_load_dwordx16 s[8:23], s[0:1], 0
    s_cmp_ge_u32 s2, 256
    s_cbranch_scc1 L_end
    s_getpc_b64 s[6:7]
    s_bfe_u32 s56, s2, 0x30003
    s_lshl_b32 s56, s56, 12
    v_lshl_add_u32 v1, v0, 4, s56
    v_min_u32 v1, L_end-standalone__mixer_token_mlp__prompt_kernel-64, v1
    global_load_dword v48, v1, s[6:7]
    v_lshrrev_b32 v2, 6, v0
    v_and_b32 v40, 63, v0
    v_readfirstlane_b32 s48, v2
    s_lshr_b32 s3, s2, 2
    s_lshl_b32 s3, s3, 15
    s_and_b32 s56, s2, 3
    s_lshl_b32 s56, s56, 12
    s_add_u32 s3, s3, s56
    v_lshl_add_u32 v3, v40, 4, s3
    v_lshrrev_b32 v1, 7, v0
    v_lshl_add_u32 v3, v1, 14, v3
    v_and_b32 v1, 1, v2
    v_lshl_add_u32 v3, v1, 11, v3
    s_bfe_u32 s49, s2, 0x20001
    s_and_b32 s59, s2, 1
    s_lshr_b32 s52, s2, 3
    s_mul_i32 s50, s52, 37
    s_lshr_b32 s50, s50, 8
    s_sub_u32 s49, s49, s50
    s_mul_i32 s49, s49, 7
    s_add_u32 s49, s49, s52
    s_lshr_b32 s55, s50, 2
    s_and_b32 s58, s52, 3
    s_cmp_lg_u32 s55, 0
    s_cselect_b32 s50, s58, s50
    s_lshl_b32 s58, s59, 2
    s_add_u32 s50, s50, s58
    s_mov_b32 s101, 0x76534210
    s_cmp_eq_u32 s50, 1
    s_cselect_b32 s101, 0x76510342, s101
    s_cmp_eq_u32 s50, 2
    s_cselect_b32 s101, 0x76315204, s101
    s_cmp_eq_u32 s50, 3
    s_cselect_b32 s101, 0x67531420, s101
    s_cmp_eq_u32 s50, 4
    s_cselect_b32 s101, 0x67425301, s101
    s_cmp_eq_u32 s50, 5
    s_cselect_b32 s101, 0x67401253, s101
    s_cmp_eq_u32 s50, 6
    s_cselect_b32 s101, 0x67204315, s101
    s_cmp_eq_u32 s50, 7
    s_cselect_b32 s101, 0x76420531, s101
    v_lshrrev_b32 v24, 3, v40
    v_and_b32 v25, 6, v24
    v_and_b32 v26, 7, v40
    v_xor_b32 v26, v25, v26
    v_lshlrev_b32 v26, 4, v26
    v_mul_u32_u24 v41, 3584, v24
    v_add_u32 v41, v41, v26
    v_mov_b32 v188, v41
    v_add_u32 v189, 27648, v41
    v_add_u32 v190, 55296, v41
    v_add_u32 v191, 82944, v41
    s_mul_i32 s60, s48, 1835008
    s_lshl_b32 s57, s49, 7
    s_add_u32 s60, s60, s57
    s_mul_i32 s53, s48, 28672
    s_add_u32 s53, s53, 49152
    s_mov_b32 s26, 0x700000
    s_mov_b32 s27, 0x20000
    s_waitcnt lgkmcnt(0)
    global_load_dwordx4 v[4:7], v3, s[8:9]
    global_load_dwordx4 v[8:11], v3, s[8:9] offset:1024
    s_mov_b64 s[24:25], s[10:11]
    s_cmp_lg_u32 s55, 0
    s_cbranch_scc1 L_idle0
    s_bfe_u32 s63, s101, 0x30000
    s_mul_i32 s63, s63, 229376
    s_add_u32 s63, s63, s60
    s_add_u32 m0, s53, 0
    s_add_u32 s56, s63, 0
    buffer_load_dwordx4 v188, s[24:27], s56 offen offset:0 lds
    buffer_load_dwordx4 v189, s[24:27], s56 offen offset:1024 lds
    buffer_load_dwordx4 v190, s[24:27], s56 offen offset:2048 lds
L_idle0:
    s_and_b32 s58, s50, 3
    s_mul_i32 s57, s58, 7
    s_sub_u32 s52, s52, s57
    s_add_u32 s52, s52, 1
    s_cmp_lg_u32 s55, 0
    s_cselect_b32 s52, 0, s52
    s_xor_b32 s58, s58, 3
    s_and_b32 s51, s2, 7
    s_lshl_b32 s51, s51, 2
    s_add_u32 s51, s51, s58
    s_lshl_b32 s58, s58, 1
    s_add_u32 s52, s52, s58
    s_and_b32 s52, s52, 7
    s_mov_b64 s[28:29], s[14:15]
    s_mov_b32 s30, 0x700000
    s_mov_b32 s31, 0x20000
    s_cmp_eq_u32 s55, 0
    s_cbranch_scc1 L_busy0
    s_waitcnt vmcnt(0)
L_busy0:
    s_add_u32 s44, s22, 0x400000
    s_addc_u32 s45, s23, 0
    s_mov_b32 s46, 0x60000
    s_mov_b32 s47, 0x20000
    s_load_dword s54, s[44:45], 0x10000
    v_lshl_add_u32 v42, v24, 12, v26
    s_mov_b64 s[32:33], s[22:23]
    s_mov_b32 s34, 0x200000
    s_mov_b32 s35, 0x20000
    s_add_u32 s36, s22, 0x200000
    s_addc_u32 s37, s23, 0
    s_mov_b32 s38, 0x200000
    s_mov_b32 s39, 0x20000
    s_mov_b64 s[40:41], s[18:19]
    s_mov_b32 s42, 0x200000
    s_mov_b32 s43, 0x20000
    v_lshlrev_b32 v12, 5, v0
    v_and_b32 v13, 0x23, v40
    v_bfe_u32 v14, v40, 2, 2
    v_lshl_add_u32 v13, v14, 3, v13
    v_bfe_u32 v14, v40, 4, 1
    v_lshl_add_u32 v13, v14, 2, v13
    v_lshlrev_b32 v13, 2, v13
    v_lshl_add_u32 v13, v2, 9, v13
    v_lshrrev_b32 v24, 4, v40
    v_and_b32 v25, 15, v40
    v_lshl_add_u32 v3, v2, 3, v24
    v_lshlrev_b32 v3, 16, v3
    v_lshl_add_u32 v3, v25, 4, v3
    s_lshl_b32 s3, s2, 8
    v_add_u32 v3, s3, v3
    v_lshlrev_b32 v56, 4, v40
    v_add_u32 v57, 0x10000, v56
    s_and_b32 s57, s48, 1
    s_lshl_b32 s57, s57, 16
    v_xor_b32 v54, s57, v56
    v_xor_b32 v55, s57, v57
    v_lshlrev_b32 v47, 10, v25
    v_lshl_add_u32 v47, v24, 4, v47
    s_lshl_b32 s58, s51, 2
    s_add_u32 s58, s58, s48
    s_lshl_b32 s100, s58, 14
    s_lshl_b32 s57, s52, 7
    s_add_u32 s100, s100, s57
    s_lshl_b32 s58, s58, 5
    v_lshl_add_u32 v15, v25, 1, s58
    s_lshl_b32 s57, s49, 1
    s_lshr_b32 s58, s48, 1
    s_add_u32 s57, s57, s58
    s_lshl_b32 s58, s57, 6
    v_lshl_add_u32 v14, v24, 3, s58
    s_lshl_b32 s62, s57, 10
    s_lshl_b32 s58, s50, 18
    s_add_u32 s62, s62, s58
    s_lshl_b32 s61, s48, 14
    s_add_u32 s61, s61, s58
    s_xor_b32 s57, s48, 1
    s_mul_i32 s57, s57, 6144
    s_add_u32 s57, s57, 0
    v_lshl_add_u32 v43, v40, 4, s57
    s_xor_b32 s57, s48, 2
    s_mul_i32 s57, s57, 6144
    s_add_u32 s57, s57, 2048
    v_lshl_add_u32 v44, v40, 4, s57
    s_xor_b32 s57, s48, 3
    s_mul_i32 s57, s57, 6144
    s_add_u32 s57, s57, 4096
    v_lshl_add_u32 v45, v40, 4, s57
    s_mul_i32 s57, s48, 6144
    v_lshl_add_u32 v46, v40, 4, s57
    s_lshl_b32 s96, s48, 11
    s_lshl_b32 s58, s2, 3
    s_add_u32 s96, s96, s58
    global_load_dwordx2 v[60:61], v14, s[12:13] offset:0
    global_load_dwordx2 v[62:63], v14, s[12:13] offset:32
    global_load_ushort v53, v15, s[16:17]
    v_lshrrev_b32 v131, 3, v40
    v_mul_u32_u24 v131, 3584, v131
    v_and_b32 v132, 7, v40
    v_min_u32 v132, 6, v132
    v_lshl_add_u32 v131, v132, 7, v131
    s_cmp_eq_u32 s55, 0
    s_cbranch_scc1 L_iw_1
    s_bfe_u32 s63, s2, 0x20001
    s_mul_i32 s63, s63, 896
    s_lshl_b32 s57, s48, 6
    s_and_b32 s58, s50, 3
    s_add_u32 s57, s57, s58
    s_add_u32 s57, s57, 48
    s_mul_i32 s57, s57, 28672
    s_add_u32 s63, s63, s57
    s_and_b32 s57, s2, 1
    s_mul_i32 s57, s57, 229376
    s_sub_u32 s97, s63, s57
    s_add_u32 s97, s97, 229376
    s_add_u32 s63, s63, s57
L_iw_1:
    s_mov_b32 s4, 0xffff0000
    s_waitcnt vmcnt(6)
    s_cmp_lg_u32 s55, 0
    s_cbranch_scc1 L_nw_2
    buffer_load_dwordx4 v191, s[24:27], s56 offen offset:3072 lds
    s_add_u32 m0, s53, 4096
    s_add_u32 s56, s63, 114688
    buffer_load_dwordx4 v188, s[24:27], s56 offen offset:0 lds
    buffer_load_dwordx4 v189, s[24:27], s56 offen offset:1024 lds
L_nw_2:
    v_lshlrev_b32 v16, 16, v4
    v_lshlrev_b32 v17, 16, v8
    v_and_b32 v18, s4, v4
    v_and_b32 v19, s4, v8
    v_lshlrev_b32 v20, 16, v5
    v_lshlrev_b32 v21, 16, v9
    v_and_b32 v22, s4, v5
    v_and_b32 v23, s4, v9
    v_lshlrev_b32 v24, 16, v6
    v_lshlrev_b32 v25, 16, v10
    v_and_b32 v26, s4, v6
    v_and_b32 v27, s4, v10
    v_lshlrev_b32 v28, 16, v7
    v_lshlrev_b32 v29, 16, v11
    v_and_b32 v30, s4, v7
    v_and_b32 v31, s4, v11
.p2align 3
    v_pk_add_f32 v[32:33], v[16:17], v[18:19]
    v_pk_add_f32 v[34:35], v[20:21], v[22:23]
    v_pk_add_f32 v[36:37], v[24:25], v[26:27]
    v_pk_add_f32 v[38:39], v[28:29], v[30:31]
    v_pk_add_f32 v[32:33], v[32:33], v[34:35]
    v_pk_add_f32 v[36:37], v[36:37], v[38:39]
    v_pk_add_f32 v[32:33], v[32:33], v[36:37]
    s_nop 1
    v_add_f32_dpp v32, v32, v32 row_shr:1 row_mask:0xf bank_mask:0xf
    v_add_f32_dpp v33, v33, v33 row_shr:1 row_mask:0xf bank_mask:0xf
    s_nop 0
    v_add_f32_dpp v32, v32, v32 row_shr:2 row_mask:0xf bank_mask:0xf
    v_add_f32_dpp v33, v33, v33 row_shr:2 row_mask:0xf bank_mask:0xf
    s_nop 0
    v_add_f32_dpp v32, v32, v32 row_shr:4 row_mask:0xf bank_mask:0xf
    v_add_f32_dpp v33, v33, v33 row_shr:4 row_mask:0xf bank_mask:0xf
    s_nop 0
    v_add_f32_dpp v32, v32, v32 row_shr:8 row_mask:0xf bank_mask:0xf
    v_add_f32_dpp v33, v33, v33 row_shr:8 row_mask:0xf bank_mask:0xf
    s_nop 0
    v_add_f32_dpp v32, v32, v32 row_bcast:15 row_mask:0xa bank_mask:0xf
    v_add_f32_dpp v33, v33, v33 row_bcast:15 row_mask:0xa bank_mask:0xf
    s_nop 0
    v_add_f32_dpp v32, v32, v32 row_bcast:31 row_mask:0xc bank_mask:0xf
    v_add_f32_dpp v33, v33, v33 row_bcast:31 row_mask:0xc bank_mask:0xf
    v_mul_f32 v32, 0x3b000000, v32
    v_mul_f32 v33, 0x3b000000, v33
    s_nop 0
    v_readlane_b32 s4, v32, 63
    v_readlane_b32 s5, v33, 63
    s_cmp_lg_u32 s55, 0
    s_cbranch_scc1 L_nw_3
    buffer_load_dwordx4 v190, s[24:27], s56 offen offset:2048 lds
    buffer_load_dwordx4 v191, s[24:27], s56 offen offset:3072 lds
L_nw_3:
    s_nop 1
.p2align 3
    v_pk_add_f32 v[16:17], v[16:17], s[4:5] neg_lo:[0,1] neg_hi:[0,1]
    v_pk_add_f32 v[18:19], v[18:19], s[4:5] neg_lo:[0,1] neg_hi:[0,1]
    v_pk_add_f32 v[20:21], v[20:21], s[4:5] neg_lo:[0,1] neg_hi:[0,1]
    v_pk_add_f32 v[22:23], v[22:23], s[4:5] neg_lo:[0,1] neg_hi:[0,1]
    v_pk_add_f32 v[24:25], v[24:25], s[4:5] neg_lo:[0,1] neg_hi:[0,1]
    v_pk_add_f32 v[26:27], v[26:27], s[4:5] neg_lo:[0,1] neg_hi:[0,1]
    v_pk_add_f32 v[28:29], v[28:29], s[4:5] neg_lo:[0,1] neg_hi:[0,1]
    v_pk_add_f32 v[30:31], v[30:31], s[4:5] neg_lo:[0,1] neg_hi:[0,1]
    v_pk_mul_f32 v[32:33], v[16:17], v[16:17]
    v_pk_mul_f32 v[34:35], v[18:19], v[18:19]
    v_pk_fma_f32 v[32:33], v[20:21], v[20:21], v[32:33]
    v_pk_fma_f32 v[34:35], v[22:23], v[22:23], v[34:35]
    v_pk_fma_f32 v[32:33], v[24:25], v[24:25], v[32:33]
    v_pk_fma_f32 v[34:35], v[26:27], v[26:27], v[34:35]
    v_pk_fma_f32 v[32:33], v[28:29], v[28:29], v[32:33]
    v_pk_fma_f32 v[34:35], v[30:31], v[30:31], v[34:35]
    v_pk_add_f32 v[32:33], v[32:33], v[34:35]
    s_nop 1
    v_add_f32_dpp v32, v32, v32 row_shr:1 row_mask:0xf bank_mask:0xf
    v_add_f32_dpp v33, v33, v33 row_shr:1 row_mask:0xf bank_mask:0xf
    s_nop 0
    v_add_f32_dpp v32, v32, v32 row_shr:2 row_mask:0xf bank_mask:0xf
    v_add_f32_dpp v33, v33, v33 row_shr:2 row_mask:0xf bank_mask:0xf
    s_nop 0
    v_add_f32_dpp v32, v32, v32 row_shr:4 row_mask:0xf bank_mask:0xf
    v_add_f32_dpp v33, v33, v33 row_shr:4 row_mask:0xf bank_mask:0xf
    s_nop 0
    v_add_f32_dpp v32, v32, v32 row_shr:8 row_mask:0xf bank_mask:0xf
    v_add_f32_dpp v33, v33, v33 row_shr:8 row_mask:0xf bank_mask:0xf
    s_nop 0
    v_add_f32_dpp v32, v32, v32 row_bcast:15 row_mask:0xa bank_mask:0xf
    v_add_f32_dpp v33, v33, v33 row_bcast:15 row_mask:0xa bank_mask:0xf
    s_nop 0
    v_add_f32_dpp v32, v32, v32 row_bcast:31 row_mask:0xc bank_mask:0xf
    v_add_f32_dpp v33, v33, v33 row_bcast:31 row_mask:0xc bank_mask:0xf
    v_mul_f32 v32, 0x3b000000, v32
    v_mul_f32 v33, 0x3b000000, v33
    v_add_f32 v32, 0x3727c5ac, v32
    v_add_f32 v33, 0x3727c5ac, v33
    v_rsq_f32 v32, v32
    v_rsq_f32 v33, v33
    s_nop 0
    v_readlane_b32 s6, v32, 63
    v_readlane_b32 s7, v33, 63
    s_nop 1
.p2align 3
    v_pk_mul_f32 v[16:17], v[16:17], s[6:7]
    v_pk_mul_f32 v[18:19], v[18:19], s[6:7]
    v_pk_mul_f32 v[20:21], v[20:21], s[6:7]
    v_pk_mul_f32 v[22:23], v[22:23], s[6:7]
    v_pk_mul_f32 v[24:25], v[24:25], s[6:7]
    v_pk_mul_f32 v[26:27], v[26:27], s[6:7]
    v_pk_mul_f32 v[28:29], v[28:29], s[6:7]
    v_pk_mul_f32 v[30:31], v[30:31], s[6:7]
    v_cvt_pk_bf16_f32 v4, v16, v17
    v_cvt_pk_bf16_f32 v5, v18, v19
    v_cvt_pk_bf16_f32 v6, v20, v21
    v_cvt_pk_bf16_f32 v7, v22, v23
    v_cvt_pk_bf16_f32 v8, v24, v25
    v_cvt_pk_bf16_f32 v9, v26, v27
    v_cvt_pk_bf16_f32 v10, v28, v29
    v_cvt_pk_bf16_f32 v11, v30, v31
    ds_write_b128 v12, v[4:7]
    ds_write_b128 v12, v[8:11] offset:16
    s_waitcnt lgkmcnt(0)
    s_barrier
    ds_read2st64_b32 v[16:17], v13 offset0:0 offset1:8
    ds_read2st64_b32 v[18:19], v13 offset0:16 offset1:24
    ds_read2st64_b32 v[20:21], v13 offset0:1 offset1:9
    ds_read2st64_b32 v[22:23], v13 offset0:17 offset1:25
    s_mul_i32 s54, s54, 0x9E3779B1
    s_add_u32 s54, s54, 0x7F4A7C15
    s_mov_b32 s57, 0x40000
    s_waitcnt lgkmcnt(2)
    buffer_store_dwordx4 v[16:19], v3, s[32:35], 0 offen sc1
    s_waitcnt lgkmcnt(0)
    buffer_store_dwordx4 v[20:23], v3, s[32:35], s57 offen sc1
    s_cmp_lg_u32 s55, 0
    s_cbranch_scc1 L_nopre
    s_bfe_u32 s63, s101, 0x30004
    s_mul_i32 s63, s63, 229376
    s_add_u32 s63, s63, s60
    s_add_u32 m0, s53, 8192
    s_add_u32 s56, s63, 0
    buffer_load_dwordx4 v188, s[24:27], s56 offen offset:0 lds
    buffer_load_dwordx4 v189, s[24:27], s56 offen offset:1024 lds
    buffer_load_dwordx4 v190, s[24:27], s56 offen offset:2048 lds
    buffer_load_dwordx4 v191, s[24:27], s56 offen offset:3072 lds
    s_add_u32 m0, s53, 12288
    s_add_u32 s56, s63, 114688
    buffer_load_dwordx4 v188, s[24:27], s56 offen offset:0 lds
    buffer_load_dwordx4 v189, s[24:27], s56 offen offset:1024 lds
    buffer_load_dwordx4 v190, s[24:27], s56 offen offset:2048 lds
    buffer_load_dwordx4 v191, s[24:27], s56 offen offset:3072 lds
L_nopre:
    v_mov_b32 v51, s54
    v_mov_b32 v36, v42
    v_add_u32 v37, 31744, v42
    v_add_u32 v38, 63488, v42
    v_add_u32 v39, 95232, v42
    v_lshlrev_b32 v52, 2, v40
    v_bfe_u32 v5, v40, 2, 3
    v_lshlrev_b32 v6, 7, v5
    v_lshrrev_b32 v5, 1, v5
    v_lshl_add_u32 v6, v5, 5, v6
    v_and_b32 v5, 3, v40
    v_lshl_add_u32 v6, v5, 3, v6
    v_lshrrev_b32 v5, 5, v40
    v_lshl_add_u32 v6, v5, 10, v6
    v_add_u32 v6, s53, v6
    s_lshl_b32 s57, s48, 5
    v_xor_b32 v180, s57, v6
    s_and_b32 s57, s57, 64
    v_xor_b32 v176, s57, v6
    v_xor_b32 v177, 32, v176
    v_xor_b32 v181, 32, v180
    v_xor_b32 v178, 64, v176
    v_xor_b32 v182, 64, v180
    v_xor_b32 v179, 96, v176
    v_xor_b32 v183, 96, v180
    s_lshl_b32 s57, s52, 12
    s_mul_i32 s58, s48, 896
    s_add_u32 s57, s57, s58
    s_add_u32 s57, s57, 0x20000
    v_min_u32 v50, 27, v40
    v_and_b32 v5, 3, v50
    v_lshrrev_b32 v50, 2, v50
    v_lshlrev_b32 v50, 7, v50
    v_add_u32 v50, s57, v50
    s_mov_b32 s3, 0x8000
    s_mul_i32 s98, s48, 1835008
    s_lshl_b32 s57, s51, 7
    s_add_u32 s98, s98, s57
    s_mul_i32 s99, s48, 14336
    s_lshl_b32 s57, s52, 18
    s_add_u32 s99, s99, s57
    s_cmp_lg_u32 s55, 0
    s_cbranch_scc1 L_idle
    s_mov_b32 s57, 0
    s_lshl_b32 s58, s48, 9
    s_add_u32 s57, s57, s58
    v_lshl_add_u32 v49, v40, 3, s57
    s_waitcnt vmcnt(8)
    s_barrier
    s_cmp_lg_u32 s48, 0
    s_cbranch_scc1 L_noep_4
    s_mov_b64 exec, 0x3
    buffer_store_dword v51, v52, s[44:47], s96 offen sc1
    s_mov_b64 exec, -1
L_noep_4:
    s_lshl_b32 s96, s50, 12
    s_lshl_b32 s57, s49, 7
    s_add_u32 s96, s96, s57
    s_lshl_b32 s57, s48, 6
    s_add_u32 s96, s96, s57
    s_add_u32 s96, s96, 0x20000
    s_bfe_u32 s63, s101, 0x30008
    s_mul_i32 s63, s63, 229376
    s_add_u32 s63, s63, s60
    s_add_u32 m0, s53, 16384
    s_add_u32 s56, s63, 0
    buffer_load_dwordx4 v188, s[24:27], s56 offen offset:0 lds
    buffer_load_dwordx4 v189, s[24:27], s56 offen offset:1024 lds
    buffer_load_dwordx4 v190, s[24:27], s56 offen offset:2048 lds
    buffer_load_dwordx4 v191, s[24:27], s56 offen offset:3072 lds
    s_add_u32 m0, s53, 20480
    s_add_u32 s56, s63, 114688
    buffer_load_dwordx4 v188, s[24:27], s56 offen offset:0 lds
    buffer_load_dwordx4 v189, s[24:27], s56 offen offset:1024 lds
    buffer_load_dwordx4 v190, s[24:27], s56 offen offset:2048 lds
    buffer_load_dwordx4 v191, s[24:27], s56 offen offset:3072 lds
    s_bfe_u32 s63, s101, 0x3000c
    s_mul_i32 s63, s63, 229376
    s_add_u32 s63, s63, s60
    s_add_u32 m0, s53, 24576
    s_add_u32 s56, s63, 0
    buffer_load_dwordx4 v188, s[24:27], s56 offen offset:0 lds
    buffer_load_dwordx4 v189, s[24:27], s56 offen offset:1024 lds
    ds_read_b64_tr_b16 a[0:1], v176 offset:0
    ds_read_b64_tr_b16 a[2:3], v176 offset:2048
    ds_read_b64_tr_b16 a[4:5], v177 offset:0
    ds_read_b64_tr_b16 a[6:7], v177 offset:2048
    ds_read_b64_tr_b16 a[8:9], v178 offset:0
    ds_read_b64_tr_b16 a[10:11], v178 offset:2048
    ds_read_b64_tr_b16 a[12:13], v179 offset:0
    ds_read_b64_tr_b16 a[14:15], v179 offset:2048
    buffer_load_dwordx4 v190, s[24:27], s56 offen offset:2048 lds
    buffer_load_dwordx4 v191, s[24:27], s56 offen offset:3072 lds
    s_waitcnt lgkmcnt(0)
    s_add_u32 m0, s53, 0
    s_add_u32 s56, s63, 114688
    buffer_load_dwordx4 v188, s[24:27], s56 offen offset:0 lds
    buffer_load_dwordx4 v189, s[24:27], s56 offen offset:1024 lds
    ds_read_b64_tr_b16 a[16:17], v176 offset:4096
    ds_read_b64_tr_b16 a[18:19], v176 offset:6144
    ds_read_b64_tr_b16 a[20:21], v177 offset:4096
    ds_read_b64_tr_b16 a[22:23], v177 offset:6144
    ds_read_b64_tr_b16 a[24:25], v178 offset:4096
    ds_read_b64_tr_b16 a[26:27], v178 offset:6144
    ds_read_b64_tr_b16 a[28:29], v179 offset:4096
    ds_read_b64_tr_b16 a[30:31], v179 offset:6144
    buffer_load_dwordx4 v190, s[24:27], s56 offen offset:2048 lds
    buffer_load_dwordx4 v191, s[24:27], s56 offen offset:3072 lds
    s_bfe_u32 s8, s101, 0x30000
    s_lshl_b32 s8, s8, 11
    s_add_u32 s8, s8, s61
    s_bfe_u32 s9, s101, 0x30004
    s_lshl_b32 s9, s9, 11
    s_add_u32 s9, s9, s61
    s_bfe_u32 s10, s101, 0x30008
    s_lshl_b32 s10, s10, 11
    s_add_u32 s10, s10, s61
    s_bfe_u32 s11, s101, 0x3000c
    s_lshl_b32 s11, s11, 11
    s_add_u32 s11, s11, s61
    s_bfe_u32 s12, s101, 0x30010
    s_lshl_b32 s12, s12, 11
    s_add_u32 s12, s12, s61
    s_bfe_u32 s13, s101, 0x30014
    s_lshl_b32 s13, s13, 11
    s_add_u32 s13, s13, s61
    s_bfe_u32 s14, s101, 0x30018
    s_lshl_b32 s14, s14, 11
    s_add_u32 s14, s14, s61
    s_bfe_u32 s15, s101, 0x3001c
    s_lshl_b32 s15, s15, 11
    s_add_u32 s15, s15, s61
    v_add_u32 v186, 0x20000, v54
    v_add_u32 v187, 0x20000, v55
    s_add_u32 s16, s99, 0
    s_add_u32 s17, s99, 4096
    s_add_u32 s18, s99, 8192
    s_add_u32 s19, s99, 12288
    v_add_u32 v184, 0x20000, v56
    v_add_u32 v185, 0x20000, v57
    v_lshlrev_b32 v160, 16, v53
    v_lshlrev_b32 v161, 16, v53
    v_lshlrev_b32 v162, 16, v53
    v_lshlrev_b32 v163, 16, v53
    s_mov_b32 s4, 0xffff0000
    v_lshlrev_b32 v152, 16, v60
    v_and_b32 v153, s4, v60
    v_lshlrev_b32 v154, 16, v61
    v_and_b32 v155, s4, v61
    v_lshlrev_b32 v156, 16, v62
    v_and_b32 v157, s4, v62
    v_lshlrev_b32 v158, 16, v63
    v_and_b32 v159, s4, v63
    s_mov_b32 s4, 0xbdd2d3e8
    s_mov_b32 s5, 0xbdd2d3e8
    v_mov_b32 v172, 0xc0135761
    v_mov_b32 v173, 0xc0135761
    s_waitcnt lgkmcnt(0)
    s_bfe_u32 s63, s101, 0x30010
    s_mul_i32 s63, s63, 229376
    s_add_u32 s63, s63, s60
    s_add_u32 m0, s53, 4096
    s_add_u32 s56, s63, 0
    buffer_load_dwordx4 v188, s[24:27], s56 offen offset:0 lds
    buffer_load_dwordx4 v189, s[24:27], s56 offen offset:1024 lds
    s_waitcnt vmcnt(22)
    ds_read_b64_tr_b16 a[32:33], v176 offset:8192
    ds_read_b64_tr_b16 a[34:35], v176 offset:10240
    ds_read_b64_tr_b16 a[36:37], v177 offset:8192
    ds_read_b64_tr_b16 a[38:39], v177 offset:10240
    ds_read_b64_tr_b16 a[40:41], v178 offset:8192
    ds_read_b64_tr_b16 a[42:43], v178 offset:10240
    ds_read_b64_tr_b16 a[44:45], v179 offset:8192
    ds_read_b64_tr_b16 a[46:47], v179 offset:10240
    buffer_load_dwordx4 v190, s[24:27], s56 offen offset:2048 lds
    buffer_load_dwordx4 v191, s[24:27], s56 offen offset:3072 lds
    s_waitcnt lgkmcnt(0)
    s_add_u32 m0, s53, 8192
    s_add_u32 s56, s63, 114688
    buffer_load_dwordx4 v188, s[24:27], s56 offen offset:0 lds
    buffer_load_dwordx4 v189, s[24:27], s56 offen offset:1024 lds
    s_waitcnt vmcnt(22)
    ds_read_b64_tr_b16 a[48:49], v176 offset:12288
    ds_read_b64_tr_b16 a[50:51], v176 offset:14336
    ds_read_b64_tr_b16 a[52:53], v177 offset:12288
    ds_read_b64_tr_b16 a[54:55], v177 offset:14336
    ds_read_b64_tr_b16 a[56:57], v178 offset:12288
    ds_read_b64_tr_b16 a[58:59], v178 offset:14336
    ds_read_b64_tr_b16 a[60:61], v179 offset:12288
    ds_read_b64_tr_b16 a[62:63], v179 offset:14336
    buffer_load_dwordx4 v190, s[24:27], s56 offen offset:2048 lds
    buffer_load_dwordx4 v191, s[24:27], s56 offen offset:3072 lds
    s_waitcnt lgkmcnt(0)
    s_bfe_u32 s63, s101, 0x30014
    s_mul_i32 s63, s63, 229376
    s_add_u32 s63, s63, s60
    s_add_u32 m0, s53, 12288
    s_add_u32 s56, s63, 0
    buffer_load_dwordx4 v188, s[24:27], s56 offen offset:0 lds
    buffer_load_dwordx4 v189, s[24:27], s56 offen offset:1024 lds
    s_waitcnt vmcnt(22)
    ds_read_b64_tr_b16 a[64:65], v176 offset:16384
    ds_read_b64_tr_b16 a[66:67], v176 offset:18432
    ds_read_b64_tr_b16 a[68:69], v177 offset:16384
    ds_read_b64_tr_b16 a[70:71], v177 offset:18432
    ds_read_b64_tr_b16 a[72:73], v178 offset:16384
    ds_read_b64_tr_b16 a[74:75], v178 offset:18432
    ds_read_b64_tr_b16 a[76:77], v179 offset:16384
    ds_read_b64_tr_b16 a[78:79], v179 offset:18432
    buffer_load_dwordx4 v190, s[24:27], s56 offen offset:2048 lds
    buffer_load_dwordx4 v191, s[24:27], s56 offen offset:3072 lds
    s_waitcnt lgkmcnt(0)
    s_add_u32 m0, s53, 16384
    s_add_u32 s56, s63, 114688
    buffer_load_dwordx4 v188, s[24:27], s56 offen offset:0 lds
    buffer_load_dwordx4 v189, s[24:27], s56 offen offset:1024 lds
    s_waitcnt vmcnt(22)
    ds_read_b64_tr_b16 a[80:81], v176 offset:20480
    ds_read_b64_tr_b16 a[82:83], v176 offset:22528
    ds_read_b64_tr_b16 a[84:85], v177 offset:20480
    ds_read_b64_tr_b16 a[86:87], v177 offset:22528
    ds_read_b64_tr_b16 a[88:89], v178 offset:20480
    ds_read_b64_tr_b16 a[90:91], v178 offset:22528
    ds_read_b64_tr_b16 a[92:93], v179 offset:20480
    ds_read_b64_tr_b16 a[94:95], v179 offset:22528
    buffer_load_dwordx4 v190, s[24:27], s56 offen offset:2048 lds
    buffer_load_dwordx4 v191, s[24:27], s56 offen offset:3072 lds
    s_waitcnt lgkmcnt(0)
    s_bfe_u32 s63, s101, 0x30018
    s_mul_i32 s63, s63, 229376
    s_add_u32 s63, s63, s60
    s_add_u32 m0, s53, 20480
    s_add_u32 s56, s63, 0
    buffer_load_dwordx4 v188, s[24:27], s56 offen offset:0 lds
    buffer_load_dwordx4 v189, s[24:27], s56 offen offset:1024 lds
    s_waitcnt vmcnt(22)
    ds_read_b64_tr_b16 a[96:97], v176 offset:24576
    ds_read_b64_tr_b16 a[98:99], v176 offset:26624
    ds_read_b64_tr_b16 a[100:101], v177 offset:24576
    ds_read_b64_tr_b16 a[102:103], v177 offset:26624
    ds_read_b64_tr_b16 a[104:105], v178 offset:24576
    ds_read_b64_tr_b16 a[106:107], v178 offset:26624
    ds_read_b64_tr_b16 a[108:109], v179 offset:24576
    ds_read_b64_tr_b16 a[110:111], v179 offset:26624
    buffer_load_dwordx4 v190, s[24:27], s56 offen offset:2048 lds
    buffer_load_dwordx4 v191, s[24:27], s56 offen offset:3072 lds
    s_waitcnt lgkmcnt(0)
    s_add_u32 m0, s53, 24576
    s_add_u32 s56, s63, 114688
    buffer_load_dwordx4 v188, s[24:27], s56 offen offset:0 lds
    buffer_load_dword v48, v49, s[44:47], 0 offen sc1
    s_waitcnt vmcnt(22)
    ds_read_b64_tr_b16 a[112:113], v176 offset:0
    ds_read_b64_tr_b16 a[114:115], v176 offset:2048
    ds_read_b64_tr_b16 a[116:117], v177 offset:0
    ds_read_b64_tr_b16 a[118:119], v177 offset:2048
    ds_read_b64_tr_b16 a[120:121], v178 offset:0
    ds_read_b64_tr_b16 a[122:123], v178 offset:2048
    ds_read_b64_tr_b16 a[124:125], v179 offset:0
    ds_read_b64_tr_b16 a[126:127], v179 offset:2048
    buffer_load_dwordx4 v189, s[24:27], s56 offen offset:1024 lds
    buffer_load_dwordx4 v190, s[24:27], s56 offen offset:2048 lds
    buffer_load_dwordx4 v191, s[24:27], s56 offen offset:3072 lds
    s_waitcnt lgkmcnt(0)
    s_bfe_u32 s63, s101, 0x3001c
    s_mul_i32 s63, s63, 229376
    s_add_u32 s63, s63, s60
    s_add_u32 m0, s53, 0
    s_add_u32 s56, s63, 0
    buffer_load_dwordx4 v188, s[24:27], s56 offen offset:0 lds
    s_waitcnt vmcnt(22)
    ds_read_b64_tr_b16 a[128:129], v176 offset:4096
    ds_read_b64_tr_b16 a[130:131], v176 offset:6144
    ds_read_b64_tr_b16 a[132:133], v177 offset:4096
    ds_read_b64_tr_b16 a[134:135], v177 offset:6144
    ds_read_b64_tr_b16 a[136:137], v178 offset:4096
    ds_read_b64_tr_b16 a[138:139], v178 offset:6144
    ds_read_b64_tr_b16 a[140:141], v179 offset:4096
    ds_read_b64_tr_b16 a[142:143], v179 offset:6144
    buffer_load_dwordx4 v189, s[24:27], s56 offen offset:1024 lds
    buffer_load_dwordx4 v190, s[24:27], s56 offen offset:2048 lds
    buffer_load_dwordx4 v191, s[24:27], s56 offen offset:3072 lds
    s_waitcnt lgkmcnt(0)
    s_add_u32 m0, s53, 4096
    s_add_u32 s56, s63, 114688
    buffer_load_dwordx4 v188, s[24:27], s56 offen offset:0 lds
    s_waitcnt vmcnt(22)
    ds_read_b64_tr_b16 a[144:145], v176 offset:8192
    ds_read_b64_tr_b16 a[146:147], v176 offset:10240
    ds_read_b64_tr_b16 a[148:149], v177 offset:8192
    ds_read_b64_tr_b16 a[150:151], v177 offset:10240
    ds_read_b64_tr_b16 a[152:153], v178 offset:8192
    ds_read_b64_tr_b16 a[154:155], v178 offset:10240
    ds_read_b64_tr_b16 a[156:157], v179 offset:8192
    ds_read_b64_tr_b16 a[158:159], v179 offset:10240
    buffer_load_dwordx4 v189, s[24:27], s56 offen offset:1024 lds
    buffer_load_dwordx4 v190, s[24:27], s56 offen offset:2048 lds
    buffer_load_dwordx4 v191, s[24:27], s56 offen offset:3072 lds
    s_waitcnt vmcnt(11)
    v_cmp_ne_u32 vcc, s54, v48
    s_cbranch_vccz L_ok_5
    s_mov_b32 s59, 200000
L_spin_6:
    s_sleep 2
    buffer_load_dword v48, v49, s[44:47], 0 offen sc1
    s_sub_u32 s59, s59, 1
    s_cbranch_scc1 L_ok_5
    s_waitcnt vmcnt(0)
    v_cmp_ne_u32 vcc, s54, v48
    s_cbranch_vccnz L_spin_6
L_ok_5:
    s_barrier
    buffer_load_dwordx4 v[64:67], v54, s[32:35], s8 offen offset:0 sc1
    ds_read_b64_tr_b16 a[160:161], v176 offset:12288
    ds_read_b64_tr_b16 a[162:163], v176 offset:14336
    ds_read_b64_tr_b16 a[164:165], v177 offset:12288
    ds_read_b64_tr_b16 a[166:167], v177 offset:14336
    ds_read_b64_tr_b16 a[168:169], v178 offset:12288
    ds_read_b64_tr_b16 a[170:171], v178 offset:14336
    ds_read_b64_tr_b16 a[172:173], v179 offset:12288
    ds_read_b64_tr_b16 a[174:175], v179 offset:14336
    buffer_load_dwordx4 v[68:71], v54, s[32:35], s8 offen offset:1024 sc1
    buffer_load_dwordx4 v[72:75], v55, s[32:35], s8 offen offset:0 sc1
    buffer_load_dwordx4 v[76:79], v55, s[32:35], s8 offen offset:1024 sc1
    buffer_load_dwordx4 v[80:83], v54, s[32:35], s9 offen offset:0 sc1
    ds_read_b64_tr_b16 a[176:177], v176 offset:16384
    ds_read_b64_tr_b16 a[178:179], v176 offset:18432
    ds_read_b64_tr_b16 a[180:181], v177 offset:16384
    ds_read_b64_tr_b16 a[182:183], v177 offset:18432
    ds_read_b64_tr_b16 a[184:185], v178 offset:16384
    ds_read_b64_tr_b16 a[186:187], v178 offset:18432
    ds_read_b64_tr_b16 a[188:189], v179 offset:16384
    ds_read_b64_tr_b16 a[190:191], v179 offset:18432
    buffer_load_dwordx4 v[84:87], v54, s[32:35], s9 offen offset:1024 sc1
    buffer_load_dwordx4 v[88:91], v55, s[32:35], s9 offen offset:0 sc1
    buffer_load_dwordx4 v[92:95], v55, s[32:35], s9 offen offset:1024 sc1
    buffer_load_dwordx4 v[96:99], v54, s[32:35], s10 offen offset:0 sc1
    ds_read_b64_tr_b16 a[192:193], v176 offset:20480
    ds_read_b64_tr_b16 a[194:195], v176 offset:22528
    ds_read_b64_tr_b16 a[196:197], v177 offset:20480
    ds_read_b64_tr_b16 a[198:199], v177 offset:22528
    ds_read_b64_tr_b16 a[200:201], v178 offset:20480
    ds_read_b64_tr_b16 a[202:203], v178 offset:22528
    ds_read_b64_tr_b16 a[204:205], v179 offset:20480
    ds_read_b64_tr_b16 a[206:207], v179 offset:22528
    buffer_load_dwordx4 v[100:103], v54, s[32:35], s10 offen offset:1024 sc1
    buffer_load_dwordx4 v[104:107], v55, s[32:35], s10 offen offset:0 sc1
    buffer_load_dwordx4 v[108:111], v55, s[32:35], s10 offen offset:1024 sc1
    s_waitcnt vmcnt(11)
    v_mfma_f32_16x16x32_bf16 v[212:215], a[12:15], v[64:67], 0
    ds_read_b64_tr_b16 a[208:209], v176 offset:24576
    ds_read_b64_tr_b16 a[210:211], v176 offset:26624
    s_waitcnt vmcnt(10)
    v_mfma_f32_16x16x32_bf16 v[212:215], a[28:31], v[68:71], v[212:215]
    ds_read_b64_tr_b16 a[212:213], v177 offset:24576
    ds_read_b64_tr_b16 a[214:215], v177 offset:26624
    v_mfma_f32_16x16x32_bf16 v[208:211], a[8:11], v[64:67], 0
    ds_read_b64_tr_b16 a[216:217], v178 offset:24576
    ds_read_b64_tr_b16 a[218:219], v178 offset:26624
    v_mfma_f32_16x16x32_bf16 v[208:211], a[24:27], v[68:71], v[208:211]
    ds_read_b64_tr_b16 a[220:221], v179 offset:24576
    ds_read_b64_tr_b16 a[222:223], v179 offset:26624
    v_mfma_f32_16x16x32_bf16 v[196:199], a[4:7], v[64:67], v[156:159]
    buffer_load_dwordx4 v[112:115], v54, s[32:35], s11 offen offset:0 sc1
    v_mfma_f32_16x16x32_bf16 v[196:199], a[20:23], v[68:71], v[196:199]
    ds_read_b64_tr_b16 a[224:225], v176 offset:0
    ds_read_b64_tr_b16 a[226:227], v176 offset:2048
    v_mfma_f32_16x16x32_bf16 v[192:195], a[0:3], v[64:67], v[152:155]
    ds_read_b64_tr_b16 a[228:229], v177 offset:0
    ds_read_b64_tr_b16 a[230:231], v177 offset:2048
    v_mfma_f32_16x16x32_bf16 v[192:195], a[16:19], v[68:71], v[192:195]
    buffer_load_dwordx4 v[116:119], v54, s[32:35], s11 offen offset:1024 sc1
    s_waitcnt vmcnt(11)
    v_mfma_f32_16x16x32_bf16 v[220:223], a[12:15], v[72:75], 0
    ds_read_b64_tr_b16 a[232:233], v178 offset:0
    ds_read_b64_tr_b16 a[234:235], v178 offset:2048
    s_waitcnt vmcnt(10)
    v_mfma_f32_16x16x32_bf16 v[220:223], a[28:31], v[76:79], v[220:223]
    ds_read_b64_tr_b16 a[236:237], v179 offset:0
    ds_read_b64_tr_b16 a[238:239], v179 offset:2048
    v_mfma_f32_16x16x32_bf16 v[216:219], a[8:11], v[72:75], 0
    ds_read_b64_tr_b16 a[240:241], v176 offset:4096
    ds_read_b64_tr_b16 a[242:243], v176 offset:6144
    v_mfma_f32_16x16x32_bf16 v[216:219], a[24:27], v[76:79], v[216:219]
    ds_read_b64_tr_b16 a[244:245], v177 offset:4096
    ds_read_b64_tr_b16 a[246:247], v177 offset:6144
    v_mfma_f32_16x16x32_bf16 v[204:207], a[4:7], v[72:75], 0
    buffer_load_dwordx4 v[120:123], v55, s[32:35], s11 offen offset:0 sc1
    v_mfma_f32_16x16x32_bf16 v[204:207], a[20:23], v[76:79], v[204:207]
    ds_read_b64_tr_b16 a[248:249], v178 offset:4096
    ds_read_b64_tr_b16 a[250:251], v178 offset:6144
    v_mfma_f32_16x16x32_bf16 v[200:203], a[0:3], v[72:75], 0
    ds_read_b64_tr_b16 a[252:253], v179 offset:4096
    ds_read_b64_tr_b16 a[254:255], v179 offset:6144
    v_mfma_f32_16x16x32_bf16 v[200:203], a[16:19], v[76:79], v[200:203]
    buffer_load_dwordx4 v[124:127], v55, s[32:35], s11 offen offset:1024 sc1
    s_waitcnt vmcnt(11)
    v_mfma_f32_16x16x32_bf16 v[212:215], a[44:47], v[80:83], v[212:215]
    s_waitcnt vmcnt(10)
    v_mfma_f32_16x16x32_bf16 v[212:215], a[60:63], v[84:87], v[212:215]
    v_mfma_f32_16x16x32_bf16 v[208:211], a[40:43], v[80:83], v[208:211]
    v_mfma_f32_16x16x32_bf16 v[208:211], a[56:59], v[84:87], v[208:211]
    v_mfma_f32_16x16x32_bf16 v[196:199], a[36:39], v[80:83], v[196:199]
    buffer_load_dwordx4 v[64:67], v54, s[32:35], s12 offen offset:0 sc1
    v_mfma_f32_16x16x32_bf16 v[196:199], a[52:55], v[84:87], v[196:199]
    v_mfma_f32_16x16x32_bf16 v[192:195], a[32:35], v[80:83], v[192:195]
    v_mfma_f32_16x16x32_bf16 v[192:195], a[48:51], v[84:87], v[192:195]
    buffer_load_dwordx4 v[68:71], v54, s[32:35], s12 offen offset:1024 sc1
    s_waitcnt vmcnt(11)
    v_mfma_f32_16x16x32_bf16 v[220:223], a[44:47], v[88:91], v[220:223]
    s_waitcnt vmcnt(10)
    v_mfma_f32_16x16x32_bf16 v[220:223], a[60:63], v[92:95], v[220:223]
    v_mfma_f32_16x16x32_bf16 v[216:219], a[40:43], v[88:91], v[216:219]
    v_mfma_f32_16x16x32_bf16 v[216:219], a[56:59], v[92:95], v[216:219]
    v_mfma_f32_16x16x32_bf16 v[204:207], a[36:39], v[88:91], v[204:207]
    buffer_load_dwordx4 v[72:75], v55, s[32:35], s12 offen offset:0 sc1
    v_mfma_f32_16x16x32_bf16 v[204:207], a[52:55], v[92:95], v[204:207]
    v_mfma_f32_16x16x32_bf16 v[200:203], a[32:35], v[88:91], v[200:203]
    v_mfma_f32_16x16x32_bf16 v[200:203], a[48:51], v[92:95], v[200:203]
    buffer_load_dwordx4 v[76:79], v55, s[32:35], s12 offen offset:1024 sc1
    s_waitcnt vmcnt(11)
    v_mfma_f32_16x16x32_bf16 v[212:215], a[76:79], v[96:99], v[212:215]
    s_waitcnt vmcnt(10)
    v_mfma_f32_16x16x32_bf16 v[212:215], a[92:95], v[100:103], v[212:215]
    v_mfma_f32_16x16x32_bf16 v[208:211], a[72:75], v[96:99], v[208:211]
    v_mfma_f32_16x16x32_bf16 v[208:211], a[88:91], v[100:103], v[208:211]
    v_mfma_f32_16x16x32_bf16 v[196:199], a[68:71], v[96:99], v[196:199]
    buffer_load_dwordx4 v[80:83], v54, s[32:35], s13 offen offset:0 sc1
    v_mfma_f32_16x16x32_bf16 v[196:199], a[84:87], v[100:103], v[196:199]
    v_mfma_f32_16x16x32_bf16 v[192:195], a[64:67], v[96:99], v[192:195]
    v_mfma_f32_16x16x32_bf16 v[192:195], a[80:83], v[100:103], v[192:195]
    buffer_load_dwordx4 v[84:87], v54, s[32:35], s13 offen offset:1024 sc1
    s_waitcnt vmcnt(11)
    v_mfma_f32_16x16x32_bf16 v[220:223], a[76:79], v[104:107], v[220:223]
    s_waitcnt vmcnt(10)
    v_mfma_f32_16x16x32_bf16 v[220:223], a[92:95], v[108:111], v[220:223]
    v_mfma_f32_16x16x32_bf16 v[216:219], a[72:75], v[104:107], v[216:219]
    v_mfma_f32_16x16x32_bf16 v[216:219], a[88:91], v[108:111], v[216:219]
    v_mfma_f32_16x16x32_bf16 v[204:207], a[68:71], v[104:107], v[204:207]
    buffer_load_dwordx4 v[88:91], v55, s[32:35], s13 offen offset:0 sc1
    v_mfma_f32_16x16x32_bf16 v[204:207], a[84:87], v[108:111], v[204:207]
    v_mfma_f32_16x16x32_bf16 v[200:203], a[64:67], v[104:107], v[200:203]
    v_mfma_f32_16x16x32_bf16 v[200:203], a[80:83], v[108:111], v[200:203]
    buffer_load_dwordx4 v[92:95], v55, s[32:35], s13 offen offset:1024 sc1
    s_waitcnt vmcnt(11)
    v_mfma_f32_16x16x32_bf16 v[212:215], a[108:111], v[112:115], v[212:215]
    s_waitcnt vmcnt(10)
    v_mfma_f32_16x16x32_bf16 v[212:215], a[124:127], v[116:119], v[212:215]
    v_mfma_f32_16x16x32_bf16 v[208:211], a[104:107], v[112:115], v[208:211]
    v_mfma_f32_16x16x32_bf16 v[208:211], a[120:123], v[116:119], v[208:211]
    v_mfma_f32_16x16x32_bf16 v[196:199], a[100:103], v[112:115], v[196:199]
    buffer_load_dwordx4 v[96:99], v54, s[32:35], s14 offen offset:0 sc1
    v_mfma_f32_16x16x32_bf16 v[196:199], a[116:119], v[116:119], v[196:199]
    v_mfma_f32_16x16x32_bf16 v[192:195], a[96:99], v[112:115], v[192:195]
    v_mfma_f32_16x16x32_bf16 v[192:195], a[112:115], v[116:119], v[192:195]
    buffer_load_dwordx4 v[100:103], v54, s[32:35], s14 offen offset:1024 sc1
    s_waitcnt vmcnt(11)
    v_mfma_f32_16x16x32_bf16 v[220:223], a[108:111], v[120:123], v[220:223]
    s_waitcnt vmcnt(10)
    v_mfma_f32_16x16x32_bf16 v[220:223], a[124:127], v[124:127], v[220:223]
    v_mfma_f32_16x16x32_bf16 v[216:219], a[104:107], v[120:123], v[216:219]
    v_mfma_f32_16x16x32_bf16 v[216:219], a[120:123], v[124:127], v[216:219]
    v_mfma_f32_16x16x32_bf16 v[204:207], a[100:103], v[120:123], v[204:207]
    buffer_load_dwordx4 v[104:107], v55, s[32:35], s14 offen offset:0 sc1
    v_mfma_f32_16x16x32_bf16 v[204:207], a[116:119], v[124:127], v[204:207]
    v_mfma_f32_16x16x32_bf16 v[200:203], a[96:99], v[120:123], v[200:203]
    v_mfma_f32_16x16x32_bf16 v[200:203], a[112:115], v[124:127], v[200:203]
    buffer_load_dwordx4 v[108:111], v55, s[32:35], s14 offen offset:1024 sc1
    s_waitcnt vmcnt(11) lgkmcnt(14)
    v_mfma_f32_16x16x32_bf16 v[212:215], a[140:143], v[64:67], v[212:215]
    s_waitcnt vmcnt(10)
    v_mfma_f32_16x16x32_bf16 v[212:215], a[156:159], v[68:71], v[212:215]
    v_mfma_f32_16x16x32_bf16 v[208:211], a[136:139], v[64:67], v[208:211]
    v_mfma_f32_16x16x32_bf16 v[208:211], a[152:155], v[68:71], v[208:211]
    v_mfma_f32_16x16x32_bf16 v[196:199], a[132:135], v[64:67], v[196:199]
    buffer_load_dwordx4 v[112:115], v54, s[32:35], s15 offen offset:0 sc1
    v_mfma_f32_16x16x32_bf16 v[196:199], a[148:151], v[68:71], v[196:199]
    v_mfma_f32_16x16x32_bf16 v[192:195], a[128:131], v[64:67], v[192:195]
    v_mfma_f32_16x16x32_bf16 v[192:195], a[144:147], v[68:71], v[192:195]
    buffer_load_dwordx4 v[116:119], v54, s[32:35], s15 offen offset:1024 sc1
    s_waitcnt vmcnt(11)
    v_mfma_f32_16x16x32_bf16 v[220:223], a[140:143], v[72:75], v[220:223]
    s_waitcnt vmcnt(10)
    v_mfma_f32_16x16x32_bf16 v[220:223], a[156:159], v[76:79], v[220:223]
    v_mfma_f32_16x16x32_bf16 v[216:219], a[136:139], v[72:75], v[216:219]
    v_mfma_f32_16x16x32_bf16 v[216:219], a[152:155], v[76:79], v[216:219]
    v_mfma_f32_16x16x32_bf16 v[204:207], a[132:135], v[72:75], v[204:207]
    buffer_load_dwordx4 v[120:123], v55, s[32:35], s15 offen offset:0 sc1
    v_mfma_f32_16x16x32_bf16 v[204:207], a[148:151], v[76:79], v[204:207]
    v_mfma_f32_16x16x32_bf16 v[200:203], a[128:131], v[72:75], v[200:203]
    v_mfma_f32_16x16x32_bf16 v[200:203], a[144:147], v[76:79], v[200:203]
    buffer_load_dwordx4 v[124:127], v55, s[32:35], s15 offen offset:1024 sc1
    s_waitcnt vmcnt(11)
    v_mfma_f32_16x16x32_bf16 v[212:215], a[172:175], v[80:83], v[212:215]
    s_waitcnt vmcnt(10)
    v_mfma_f32_16x16x32_bf16 v[212:215], a[188:191], v[84:87], v[212:215]
    v_mfma_f32_16x16x32_bf16 v[208:211], a[168:171], v[80:83], v[208:211]
    v_mfma_f32_16x16x32_bf16 v[208:211], a[184:187], v[84:87], v[208:211]
    v_mfma_f32_16x16x32_bf16 v[196:199], a[164:167], v[80:83], v[196:199]
    buffer_load_dwordx4 v[64:67], v187, s[32:35], s8 offen offset:0 sc1
    v_mfma_f32_16x16x32_bf16 v[196:199], a[180:183], v[84:87], v[196:199]
    v_mfma_f32_16x16x32_bf16 v[192:195], a[160:163], v[80:83], v[192:195]
    v_mfma_f32_16x16x32_bf16 v[192:195], a[176:179], v[84:87], v[192:195]
    buffer_load_dwordx4 v[68:71], v187, s[32:35], s8 offen offset:1024 sc1
    s_waitcnt vmcnt(11)
    v_mfma_f32_16x16x32_bf16 v[220:223], a[172:175], v[88:91], v[220:223]
    s_waitcnt vmcnt(10)
    v_mfma_f32_16x16x32_bf16 v[220:223], a[188:191], v[92:95], v[220:223]
    v_mfma_f32_16x16x32_bf16 v[216:219], a[168:171], v[88:91], v[216:219]
    v_mfma_f32_16x16x32_bf16 v[216:219], a[184:187], v[92:95], v[216:219]
    v_mfma_f32_16x16x32_bf16 v[204:207], a[164:167], v[88:91], v[204:207]
    buffer_load_dwordx4 v[72:75], v187, s[32:35], s9 offen offset:0 sc1
    v_mfma_f32_16x16x32_bf16 v[204:207], a[180:183], v[92:95], v[204:207]
    v_mfma_f32_16x16x32_bf16 v[200:203], a[160:163], v[88:91], v[200:203]
    v_mfma_f32_16x16x32_bf16 v[200:203], a[176:179], v[92:95], v[200:203]
    buffer_load_dwordx4 v[76:79], v187, s[32:35], s9 offen offset:1024 sc1
    s_waitcnt vmcnt(11)
    v_mfma_f32_16x16x32_bf16 v[212:215], a[204:207], v[96:99], v[212:215]
    s_waitcnt vmcnt(10)
    v_mfma_f32_16x16x32_bf16 v[212:215], a[220:223], v[100:103], v[212:215]
    v_mfma_f32_16x16x32_bf16 v[208:211], a[200:203], v[96:99], v[208:211]
    v_mfma_f32_16x16x32_bf16 v[208:211], a[216:219], v[100:103], v[208:211]
    v_mfma_f32_16x16x32_bf16 v[196:199], a[196:199], v[96:99], v[196:199]
    buffer_load_dwordx4 v[80:83], v187, s[32:35], s10 offen offset:0 sc1
    v_mfma_f32_16x16x32_bf16 v[196:199], a[212:215], v[100:103], v[196:199]
    v_mfma_f32_16x16x32_bf16 v[192:195], a[192:195], v[96:99], v[192:195]
    v_mfma_f32_16x16x32_bf16 v[192:195], a[208:211], v[100:103], v[192:195]
    buffer_load_dwordx4 v[84:87], v187, s[32:35], s10 offen offset:1024 sc1
    s_waitcnt vmcnt(11)
    v_mfma_f32_16x16x32_bf16 v[220:223], a[204:207], v[104:107], v[220:223]
    s_waitcnt vmcnt(10)
    v_mfma_f32_16x16x32_bf16 v[220:223], a[220:223], v[108:111], v[220:223]
    v_mfma_f32_16x16x32_bf16 v[216:219], a[200:203], v[104:107], v[216:219]
    v_mfma_f32_16x16x32_bf16 v[216:219], a[216:219], v[108:111], v[216:219]
    v_mfma_f32_16x16x32_bf16 v[204:207], a[196:199], v[104:107], v[204:207]
    buffer_load_dwordx4 v[88:91], v187, s[32:35], s11 offen offset:0 sc1
    v_mfma_f32_16x16x32_bf16 v[204:207], a[212:215], v[108:111], v[204:207]
    v_mfma_f32_16x16x32_bf16 v[200:203], a[192:195], v[104:107], v[200:203]
    v_mfma_f32_16x16x32_bf16 v[200:203], a[208:211], v[108:111], v[200:203]
    buffer_load_dwordx4 v[92:95], v187, s[32:35], s11 offen offset:1024 sc1
    s_waitcnt vmcnt(11) lgkmcnt(0)
    v_mfma_f32_16x16x32_bf16 v[212:215], a[236:239], v[112:115], v[212:215]
    s_waitcnt vmcnt(10)
    v_mfma_f32_16x16x32_bf16 v[212:215], a[252:255], v[116:119], v[212:215]
    v_mfma_f32_16x16x32_bf16 v[208:211], a[232:235], v[112:115], v[208:211]
    v_mfma_f32_16x16x32_bf16 v[208:211], a[248:251], v[116:119], v[208:211]
    v_mfma_f32_16x16x32_bf16 v[196:199], a[228:231], v[112:115], v[196:199]
    buffer_load_dwordx4 v[96:99], v187, s[32:35], s12 offen offset:0 sc1
    v_mfma_f32_16x16x32_bf16 v[196:199], a[244:247], v[116:119], v[196:199]
    v_mfma_f32_16x16x32_bf16 v[192:195], a[224:227], v[112:115], v[192:195]
    v_mfma_f32_16x16x32_bf16 v[192:195], a[240:243], v[116:119], v[192:195]
    buffer_load_dwordx4 v[100:103], v187, s[32:35], s12 offen offset:1024 sc1
    s_waitcnt vmcnt(11)
    v_mfma_f32_16x16x32_bf16 v[220:223], a[236:239], v[120:123], v[220:223]
    s_waitcnt vmcnt(10)
    v_mfma_f32_16x16x32_bf16 v[220:223], a[252:255], v[124:127], v[220:223]
    v_mfma_f32_16x16x32_bf16 v[216:219], a[232:235], v[120:123], v[216:219]
    v_mfma_f32_16x16x32_bf16 v[216:219], a[248:251], v[124:127], v[216:219]
    v_mfma_f32_16x16x32_bf16 v[204:207], a[228:231], v[120:123], v[204:207]
    buffer_load_dwordx4 v[104:107], v187, s[32:35], s13 offen offset:0 sc1
    v_mfma_f32_16x16x32_bf16 v[204:207], a[244:247], v[124:127], v[204:207]
    v_mfma_f32_16x16x32_bf16 v[200:203], a[224:227], v[120:123], v[200:203]
    v_mfma_f32_16x16x32_bf16 v[200:203], a[240:243], v[124:127], v[200:203]
    buffer_load_dwordx4 v[108:111], v187, s[32:35], s13 offen offset:1024 sc1
    s_waitcnt vmcnt(11)
    v_mfma_f32_16x16x32_bf16 v[252:255], a[12:15], v[64:67], 0
    s_waitcnt vmcnt(10)
    v_mfma_f32_16x16x32_bf16 v[252:255], a[28:31], v[68:71], v[252:255]
    v_mfma_f32_16x16x32_bf16 v[248:251], a[8:11], v[64:67], 0
    v_mfma_f32_16x16x32_bf16 v[248:251], a[24:27], v[68:71], v[248:251]
    v_mfma_f32_16x16x32_bf16 v[236:239], a[4:7], v[64:67], 0
    buffer_load_dwordx4 v[112:115], v187, s[32:35], s14 offen offset:0 sc1
    v_mfma_f32_16x16x32_bf16 v[236:239], a[20:23], v[68:71], v[236:239]
    ds_write_b128 v45, v[216:219] offset:0
    v_mfma_f32_16x16x32_bf16 v[232:235], a[0:3], v[64:67], 0
    v_mfma_f32_16x16x32_bf16 v[232:235], a[16:19], v[68:71], v[232:235]
    buffer_load_dwordx4 v[116:119], v187, s[32:35], s14 offen offset:1024 sc1
    s_waitcnt vmcnt(11)
    v_mfma_f32_16x16x32_bf16 v[252:255], a[44:47], v[72:75], v[252:255]
    ds_write_b128 v45, v[220:223] offset:1024
    s_waitcnt vmcnt(10)
    v_mfma_f32_16x16x32_bf16 v[252:255], a[60:63], v[76:79], v[252:255]
    v_mfma_f32_16x16x32_bf16 v[248:251], a[40:43], v[72:75], v[248:251]
    v_mfma_f32_16x16x32_bf16 v[248:251], a[56:59], v[76:79], v[248:251]
    v_mfma_f32_16x16x32_bf16 v[236:239], a[36:39], v[72:75], v[236:239]
    buffer_load_dwordx4 v[120:123], v187, s[32:35], s15 offen offset:0 sc1
    v_mfma_f32_16x16x32_bf16 v[236:239], a[52:55], v[76:79], v[236:239]
    ds_write_b128 v44, v[208:211] offset:0
    v_mfma_f32_16x16x32_bf16 v[232:235], a[32:35], v[72:75], v[232:235]
    v_mfma_f32_16x16x32_bf16 v[232:235], a[48:51], v[76:79], v[232:235]
    buffer_load_dwordx4 v[124:127], v187, s[32:35], s15 offen offset:1024 sc1
    s_waitcnt vmcnt(11)
    v_mfma_f32_16x16x32_bf16 v[252:255], a[76:79], v[80:83], v[252:255]
    ds_write_b128 v44, v[212:215] offset:1024
    s_waitcnt vmcnt(10)
    v_mfma_f32_16x16x32_bf16 v[252:255], a[92:95], v[84:87], v[252:255]
    v_mfma_f32_16x16x32_bf16 v[248:251], a[72:75], v[80:83], v[248:251]
    v_mfma_f32_16x16x32_bf16 v[248:251], a[88:91], v[84:87], v[248:251]
    v_mfma_f32_16x16x32_bf16 v[236:239], a[68:71], v[80:83], v[236:239]
    buffer_load_dwordx4 v[64:67], v186, s[32:35], s8 offen offset:0 sc1
    v_mfma_f32_16x16x32_bf16 v[236:239], a[84:87], v[84:87], v[236:239]
    ds_write_b128 v43, v[200:203] offset:0
    v_mfma_f32_16x16x32_bf16 v[232:235], a[64:67], v[80:83], v[232:235]
    v_mfma_f32_16x16x32_bf16 v[232:235], a[80:83], v[84:87], v[232:235]
    buffer_load_dwordx4 v[68:71], v186, s[32:35], s8 offen offset:1024 sc1
    s_waitcnt vmcnt(11)
    v_mfma_f32_16x16x32_bf16 v[252:255], a[108:111], v[88:91], v[252:255]
    ds_write_b128 v43, v[204:207] offset:1024
    s_waitcnt vmcnt(10)
    v_mfma_f32_16x16x32_bf16 v[252:255], a[124:127], v[92:95], v[252:255]
    v_mfma_f32_16x16x32_bf16 v[248:251], a[104:107], v[88:91], v[248:251]
    v_mfma_f32_16x16x32_bf16 v[248:251], a[120:123], v[92:95], v[248:251]
    v_mfma_f32_16x16x32_bf16 v[236:239], a[100:103], v[88:91], v[236:239]
    buffer_load_dwordx4 v[72:75], v186, s[32:35], s9 offen offset:0 sc1
    v_mfma_f32_16x16x32_bf16 v[236:239], a[116:119], v[92:95], v[236:239]
    v_mfma_f32_16x16x32_bf16 v[232:235], a[96:99], v[88:91], v[232:235]
    v_mfma_f32_16x16x32_bf16 v[232:235], a[112:115], v[92:95], v[232:235]
    buffer_load_dwordx4 v[76:79], v186, s[32:35], s9 offen offset:1024 sc1
    s_waitcnt vmcnt(11)
    v_mfma_f32_16x16x32_bf16 v[252:255], a[140:143], v[96:99], v[252:255]
    s_waitcnt lgkmcnt(0)
    s_barrier
    s_waitcnt vmcnt(10)
    v_mfma_f32_16x16x32_bf16 v[252:255], a[156:159], v[100:103], v[252:255]
    ds_read_b128 v[128:131], v46 offset:0
    ds_read_b128 v[132:135], v46 offset:1024
    v_mfma_f32_16x16x32_bf16 v[248:251], a[136:139], v[96:99], v[248:251]
    ds_read_b128 v[136:139], v46 offset:2048
    ds_read_b128 v[140:143], v46 offset:3072
    v_mfma_f32_16x16x32_bf16 v[248:251], a[152:155], v[100:103], v[248:251]
    ds_read_b128 v[144:147], v46 offset:4096
    ds_read_b128 v[148:151], v46 offset:5120
    v_mfma_f32_16x16x32_bf16 v[236:239], a[132:135], v[96:99], v[236:239]
    buffer_load_dwordx4 v[80:83], v186, s[32:35], s10 offen offset:0 sc1
    v_mfma_f32_16x16x32_bf16 v[236:239], a[148:151], v[100:103], v[236:239]
    v_mfma_f32_16x16x32_bf16 v[232:235], a[128:131], v[96:99], v[232:235]
    v_mfma_f32_16x16x32_bf16 v[232:235], a[144:147], v[100:103], v[232:235]
    buffer_load_dwordx4 v[84:87], v186, s[32:35], s10 offen offset:1024 sc1
    s_waitcnt vmcnt(11)
    v_mfma_f32_16x16x32_bf16 v[252:255], a[172:175], v[104:107], v[252:255]
    s_waitcnt lgkmcnt(4)
    v_add_f32 v192, v192, v128
    v_add_f32 v193, v193, v129
    s_waitcnt vmcnt(10)
    v_mfma_f32_16x16x32_bf16 v[252:255], a[188:191], v[108:111], v[252:255]
    v_add_f32 v194, v194, v130
    v_add_f32 v195, v195, v131
    v_mfma_f32_16x16x32_bf16 v[248:251], a[168:171], v[104:107], v[248:251]
    v_add_f32 v196, v196, v132
    v_add_f32 v197, v197, v133
    v_mfma_f32_16x16x32_bf16 v[248:251], a[184:187], v[108:111], v[248:251]
    v_add_f32 v198, v198, v134
    v_add_f32 v199, v199, v135
    v_mfma_f32_16x16x32_bf16 v[236:239], a[164:167], v[104:107], v[236:239]
    buffer_load_dwordx4 v[88:91], v186, s[32:35], s11 offen offset:0 sc1
    v_mfma_f32_16x16x32_bf16 v[236:239], a[180:183], v[108:111], v[236:239]
    s_waitcnt lgkmcnt(2)
    v_add_f32 v192, v192, v136
    v_add_f32 v193, v193, v137
    v_mfma_f32_16x16x32_bf16 v[232:235], a[160:163], v[104:107], v[232:235]
    v_add_f32 v194, v194, v138
    v_add_f32 v195, v195, v139
    v_mfma_f32_16x16x32_bf16 v[232:235], a[176:179], v[108:111], v[232:235]
    buffer_load_dwordx4 v[92:95], v186, s[32:35], s11 offen offset:1024 sc1
    s_waitcnt vmcnt(11)
    v_mfma_f32_16x16x32_bf16 v[252:255], a[204:207], v[112:115], v[252:255]
    v_add_f32 v196, v196, v140
    v_add_f32 v197, v197, v141
    s_waitcnt vmcnt(10)
    v_mfma_f32_16x16x32_bf16 v[252:255], a[220:223], v[116:119], v[252:255]
    v_add_f32 v198, v198, v142
    v_add_f32 v199, v199, v143
    v_mfma_f32_16x16x32_bf16 v[248:251], a[200:203], v[112:115], v[248:251]
    s_waitcnt lgkmcnt(0)
    v_add_f32 v192, v192, v144
    v_add_f32 v193, v193, v145
    v_mfma_f32_16x16x32_bf16 v[248:251], a[216:219], v[116:119], v[248:251]
    v_add_f32 v194, v194, v146
    v_add_f32 v195, v195, v147
    v_mfma_f32_16x16x32_bf16 v[236:239], a[196:199], v[112:115], v[236:239]
    buffer_load_dwordx4 v[96:99], v186, s[32:35], s12 offen offset:0 sc1
    v_mfma_f32_16x16x32_bf16 v[236:239], a[212:215], v[116:119], v[236:239]
    v_add_f32 v196, v196, v148
    v_add_f32 v197, v197, v149
    v_mfma_f32_16x16x32_bf16 v[232:235], a[192:195], v[112:115], v[232:235]
    v_add_f32 v198, v198, v150
    v_add_f32 v199, v199, v151
    v_mfma_f32_16x16x32_bf16 v[232:235], a[208:211], v[116:119], v[232:235]
    buffer_load_dwordx4 v[100:103], v186, s[32:35], s12 offen offset:1024 sc1
    s_waitcnt vmcnt(11)
    v_mfma_f32_16x16x32_bf16 v[252:255], a[236:239], v[120:123], v[252:255]
    v_mul_f32 v4, v192, v192
    v_mul_f32 v5, v193, v193
    s_waitcnt vmcnt(10)
    v_mfma_f32_16x16x32_bf16 v[252:255], a[252:255], v[124:127], v[252:255]
    v_mul_f32 v6, v194, v194
    v_mul_f32 v7, v195, v195
    v_mfma_f32_16x16x32_bf16 v[248:251], a[232:235], v[120:123], v[248:251]
    v_mul_f32 v8, v196, v196
    v_mul_f32 v9, v197, v197
    v_mfma_f32_16x16x32_bf16 v[248:251], a[248:251], v[124:127], v[248:251]
    v_mul_f32 v10, v198, v198
    v_mul_f32 v11, v199, v199
    v_mfma_f32_16x16x32_bf16 v[236:239], a[228:231], v[120:123], v[236:239]
    buffer_load_dwordx4 v[104:107], v186, s[32:35], s13 offen offset:0 sc1
    v_mfma_f32_16x16x32_bf16 v[236:239], a[244:247], v[124:127], v[236:239]
    v_fma_f32 v4, v4, s4, v172
    v_fma_f32 v5, v5, s4, v173
    v_mfma_f32_16x16x32_bf16 v[232:235], a[224:227], v[120:123], v[232:235]
    v_fma_f32 v6, v6, s4, v172
    v_fma_f32 v7, v7, s4, v173
    v_mfma_f32_16x16x32_bf16 v[232:235], a[240:243], v[124:127], v[232:235]
    buffer_load_dwordx4 v[108:111], v186, s[32:35], s13 offen offset:1024 sc1
    s_waitcnt vmcnt(11)
    v_mfma_f32_16x16x32_bf16 v[244:247], a[12:15], v[64:67], 0
    v_fma_f32 v8, v8, s4, v172
    v_fma_f32 v9, v9, s4, v173
    s_waitcnt vmcnt(10)
    v_mfma_f32_16x16x32_bf16 v[244:247], a[28:31], v[68:71], v[244:247]
    v_fma_f32 v10, v10, s4, v172
    v_fma_f32 v11, v11, s4, v173
    v_mfma_f32_16x16x32_bf16 v[240:243], a[8:11], v[64:67], 0
    v_mul_f32 v4, v4, v192
    v_mul_f32 v5, v5, v193
    v_mfma_f32_16x16x32_bf16 v[240:243], a[24:27], v[68:71], v[240:243]
    v_mul_f32 v6, v6, v194
    v_mul_f32 v7, v7, v195
    v_mfma_f32_16x16x32_bf16 v[228:231], a[4:7], v[64:67], v[156:159]
    buffer_load_dwordx4 v[112:115], v186, s[32:35], s14 offen offset:0 sc1
    v_mfma_f32_16x16x32_bf16 v[228:231], a[20:23], v[68:71], v[228:231]
    ds_write_b128 v45, v[248:251] offset:24576
    v_mfma_f32_16x16x32_bf16 v[224:227], a[0:3], v[64:67], v[152:155]
    v_mul_f32 v8, v8, v196
    v_mul_f32 v9, v9, v197
    v_mfma_f32_16x16x32_bf16 v[224:227], a[16:19], v[68:71], v[224:227]
    buffer_load_dwordx4 v[116:119], v186, s[32:35], s14 offen offset:1024 sc1
    s_waitcnt vmcnt(11)
    v_mfma_f32_16x16x32_bf16 v[244:247], a[44:47], v[72:75], v[244:247]
    v_mul_f32 v10, v10, v198
    v_mul_f32 v11, v11, v199
    s_waitcnt vmcnt(10)
    v_mfma_f32_16x16x32_bf16 v[244:247], a[60:63], v[76:79], v[244:247]
    ds_write_b128 v45, v[252:255] offset:25600
    v_mfma_f32_16x16x32_bf16 v[240:243], a[40:43], v[72:75], v[240:243]
    v_exp_f32 v4, v4
    v_mfma_f32_16x16x32_bf16 v[240:243], a[56:59], v[76:79], v[240:243]
    v_exp_f32 v5, v5
    v_mfma_f32_16x16x32_bf16 v[228:231], a[36:39], v[72:75], v[228:231]
    buffer_load_dwordx4 v[120:123], v186, s[32:35], s15 offen offset:0 sc1
    v_mfma_f32_16x16x32_bf16 v[228:231], a[52:55], v[76:79], v[228:231]
    ds_write_b128 v43, v[232:235] offset:24576
    v_mfma_f32_16x16x32_bf16 v[224:227], a[32:35], v[72:75], v[224:227]
    v_exp_f32 v6, v6
    v_mfma_f32_16x16x32_bf16 v[224:227], a[48:51], v[76:79], v[224:227]
    buffer_load_dwordx4 v[124:127], v186, s[32:35], s15 offen offset:1024 sc1
    s_waitcnt vmcnt(11)
    v_mfma_f32_16x16x32_bf16 v[244:247], a[76:79], v[80:83], v[244:247]
    v_exp_f32 v7, v7
    s_waitcnt vmcnt(10)
    v_mfma_f32_16x16x32_bf16 v[244:247], a[92:95], v[84:87], v[244:247]
    ds_write_b128 v43, v[236:239] offset:25600
    v_mfma_f32_16x16x32_bf16 v[240:243], a[72:75], v[80:83], v[240:243]
    v_exp_f32 v8, v8
    v_mfma_f32_16x16x32_bf16 v[240:243], a[88:91], v[84:87], v[240:243]
    v_exp_f32 v9, v9
    v_mfma_f32_16x16x32_bf16 v[228:231], a[68:71], v[80:83], v[228:231]
    s_add_u32 m0, s53, 8192
    s_add_u32 s56, s98, 0
    buffer_load_dwordx4 v36, s[28:31], s56 offen offset:0 lds
    v_mfma_f32_16x16x32_bf16 v[228:231], a[84:87], v[84:87], v[228:231]
    v_exp_f32 v10, v10
    v_mfma_f32_16x16x32_bf16 v[224:227], a[64:67], v[80:83], v[224:227]
    v_exp_f32 v11, v11
    v_mfma_f32_16x16x32_bf16 v[224:227], a[80:83], v[84:87], v[224:227]
    buffer_load_dwordx4 v37, s[28:31], s56 offen offset:1024 lds
    s_waitcnt vmcnt(11)
    v_mfma_f32_16x16x32_bf16 v[244:247], a[108:111], v[88:91], v[244:247]
    v_add_f32 v4, 1.0, v4
    v_add_f32 v5, 1.0, v5
    s_waitcnt vmcnt(10)
    v_mfma_f32_16x16x32_bf16 v[244:247], a[124:127], v[92:95], v[244:247]
    v_add_f32 v6, 1.0, v6
    v_add_f32 v7, 1.0, v7
    v_mfma_f32_16x16x32_bf16 v[240:243], a[104:107], v[88:91], v[240:243]
    v_add_f32 v8, 1.0, v8
    v_add_f32 v9, 1.0, v9
    v_mfma_f32_16x16x32_bf16 v[240:243], a[120:123], v[92:95], v[240:243]
    v_add_f32 v10, 1.0, v10
    v_add_f32 v11, 1.0, v11
    v_mfma_f32_16x16x32_bf16 v[228:231], a[100:103], v[88:91], v[228:231]
    buffer_load_dwordx4 v38, s[28:31], s56 offen offset:2048 lds
    v_mfma_f32_16x16x32_bf16 v[228:231], a[116:119], v[92:95], v[228:231]
    v_rcp_f32 v4, v4
    v_mfma_f32_16x16x32_bf16 v[224:227], a[96:99], v[88:91], v[224:227]
    v_rcp_f32 v5, v5
    v_mfma_f32_16x16x32_bf16 v[224:227], a[112:115], v[92:95], v[224:227]
    buffer_load_dwordx4 v39, s[28:31], s56 offen offset:3072 lds
    s_waitcnt vmcnt(11)
    v_mfma_f32_16x16x32_bf16 v[244:247], a[140:143], v[96:99], v[244:247]
    v_rcp_f32 v6, v6
    s_waitcnt vmcnt(10)
    v_mfma_f32_16x16x32_bf16 v[244:247], a[156:159], v[100:103], v[244:247]
    v_rcp_f32 v7, v7
    v_mfma_f32_16x16x32_bf16 v[240:243], a[136:139], v[96:99], v[240:243]
    v_rcp_f32 v8, v8
    v_mfma_f32_16x16x32_bf16 v[240:243], a[152:155], v[100:103], v[240:243]
    v_rcp_f32 v9, v9
    v_mfma_f32_16x16x32_bf16 v[228:231], a[132:135], v[96:99], v[228:231]
    s_add_u32 m0, s53, 12288
    s_add_u32 s56, s98, 131072
    buffer_load_dwordx4 v36, s[28:31], s56 offen offset:0 lds
    v_mfma_f32_16x16x32_bf16 v[228:231], a[148:151], v[100:103], v[228:231]
    v_rcp_f32 v10, v10
    v_mfma_f32_16x16x32_bf16 v[224:227], a[128:131], v[96:99], v[224:227]
    v_rcp_f32 v11, v11
    v_mfma_f32_16x16x32_bf16 v[224:227], a[144:147], v[100:103], v[224:227]
    buffer_load_dwordx4 v37, s[28:31], s56 offen offset:1024 lds
    s_waitcnt vmcnt(11)
    v_mfma_f32_16x16x32_bf16 v[244:247], a[172:175], v[104:107], v[244:247]
    v_mul_f32 v4, v4, v192
    v_mul_f32 v5, v5, v193
    s_waitcnt vmcnt(10)
    v_mfma_f32_16x16x32_bf16 v[244:247], a[188:191], v[108:111], v[244:247]
    v_mul_f32 v6, v6, v194
    v_mul_f32 v7, v7, v195
    v_mfma_f32_16x16x32_bf16 v[240:243], a[168:171], v[104:107], v[240:243]
    v_mul_f32 v8, v8, v196
    v_mul_f32 v9, v9, v197
    v_mfma_f32_16x16x32_bf16 v[240:243], a[184:187], v[108:111], v[240:243]
    v_mul_f32 v10, v10, v198
    v_mul_f32 v11, v11, v199
    v_mfma_f32_16x16x32_bf16 v[228:231], a[164:167], v[104:107], v[228:231]
    buffer_load_dwordx4 v38, s[28:31], s56 offen offset:2048 lds
    v_mfma_f32_16x16x32_bf16 v[228:231], a[180:183], v[108:111], v[228:231]
    v_cvt_pk_bf16_f32 v164, v4, v5
    v_cvt_pk_bf16_f32 v165, v6, v7
    v_mfma_f32_16x16x32_bf16 v[224:227], a[160:163], v[104:107], v[224:227]
    v_cvt_pk_bf16_f32 v166, v8, v9
    v_cvt_pk_bf16_f32 v167, v10, v11
    v_mfma_f32_16x16x32_bf16 v[224:227], a[176:179], v[108:111], v[224:227]
    buffer_load_dwordx4 v39, s[28:31], s56 offen offset:3072 lds
    s_waitcnt vmcnt(11)
    v_mfma_f32_16x16x32_bf16 v[244:247], a[204:207], v[112:115], v[244:247]
    buffer_store_dwordx4 v[164:167], v54, s[36:39], s62 offen sc1
    s_add_u32 s62, s62, 0x20000
    s_waitcnt vmcnt(11)
    v_mfma_f32_16x16x32_bf16 v[244:247], a[220:223], v[116:119], v[244:247]
    v_mfma_f32_16x16x32_bf16 v[240:243], a[200:203], v[112:115], v[240:243]
    v_mfma_f32_16x16x32_bf16 v[240:243], a[216:219], v[116:119], v[240:243]
    v_mfma_f32_16x16x32_bf16 v[228:231], a[196:199], v[112:115], v[228:231]
    s_add_u32 m0, s53, 16384
    s_add_u32 s56, s98, 262144
    buffer_load_dwordx4 v36, s[28:31], s56 offen offset:0 lds
    v_mfma_f32_16x16x32_bf16 v[228:231], a[212:215], v[116:119], v[228:231]
    v_mfma_f32_16x16x32_bf16 v[224:227], a[192:195], v[112:115], v[224:227]
    v_mfma_f32_16x16x32_bf16 v[224:227], a[208:211], v[116:119], v[224:227]
    s_waitcnt vmcnt(11)
    v_mfma_f32_16x16x32_bf16 v[244:247], a[236:239], v[120:123], v[244:247]
    buffer_load_dwordx4 v37, s[28:31], s56 offen offset:1024 lds
    v_mfma_f32_16x16x32_bf16 v[240:243], a[232:235], v[120:123], v[240:243]
    v_mfma_f32_16x16x32_bf16 v[228:231], a[228:231], v[120:123], v[228:231]
    v_mfma_f32_16x16x32_bf16 v[224:227], a[224:227], v[120:123], v[224:227]
    s_waitcnt vmcnt(11)
    v_mfma_f32_16x16x32_bf16 v[244:247], a[252:255], v[124:127], v[244:247]
    buffer_load_dwordx4 v38, s[28:31], s56 offen offset:2048 lds
    v_mfma_f32_16x16x32_bf16 v[240:243], a[248:251], v[124:127], v[240:243]
    v_mfma_f32_16x16x32_bf16 v[228:231], a[244:247], v[124:127], v[228:231]
    v_mfma_f32_16x16x32_bf16 v[224:227], a[240:243], v[124:127], v[224:227]
    buffer_load_dwordx4 v39, s[28:31], s56 offen offset:3072 lds
    s_nop 7
    ds_write_b128 v44, v[240:243] offset:24576
    ds_write_b128 v44, v[244:247] offset:25600
    s_waitcnt lgkmcnt(0)
    s_add_u32 m0, s53, 20480
    s_add_u32 s56, s98, 393216
    buffer_load_dwordx4 v36, s[28:31], s56 offen offset:0 lds
    buffer_load_dwordx4 v37, s[28:31], s56 offen offset:1024 lds
    buffer_load_dwordx4 v38, s[28:31], s56 offen offset:2048 lds
    s_barrier
    ds_read_b128 v[128:131], v46 offset:24576
    ds_read_b128 v[132:135], v46 offset:25600
    ds_read_b128 v[136:139], v46 offset:26624
    ds_read_b128 v[140:143], v46 offset:27648
    ds_read_b128 v[144:147], v46 offset:28672
    ds_read_b128 v[148:151], v46 offset:29696
    buffer_load_dwordx4 v39, s[28:31], s56 offen offset:3072 lds
    s_add_u32 m0, s53, 24576
    s_add_u32 s56, s98, 524288
    buffer_load_dwordx4 v36, s[28:31], s56 offen offset:0 lds
    buffer_load_dwordx4 v37, s[28:31], s56 offen offset:1024 lds
    buffer_load_dwordx4 v38, s[28:31], s56 offen offset:2048 lds
    buffer_load_dwordx4 v39, s[28:31], s56 offen offset:3072 lds
    s_waitcnt lgkmcnt(4)
    v_pk_add_f32 v[224:225], v[224:225], v[128:129]
    v_pk_add_f32 v[226:227], v[226:227], v[130:131]
    v_pk_add_f32 v[228:229], v[228:229], v[132:133]
    v_pk_add_f32 v[230:231], v[230:231], v[134:135]
    s_waitcnt lgkmcnt(2)
    v_pk_add_f32 v[224:225], v[224:225], v[136:137]
    v_pk_add_f32 v[226:227], v[226:227], v[138:139]
    v_pk_add_f32 v[228:229], v[228:229], v[140:141]
    v_pk_add_f32 v[230:231], v[230:231], v[142:143]
    s_waitcnt lgkmcnt(0)
    v_pk_add_f32 v[224:225], v[224:225], v[144:145]
    v_pk_add_f32 v[226:227], v[226:227], v[146:147]
    v_pk_add_f32 v[228:229], v[228:229], v[148:149]
    v_pk_add_f32 v[230:231], v[230:231], v[150:151]
    v_pk_mul_f32 v[4:5], v[224:225], v[224:225]
    v_pk_mul_f32 v[6:7], v[226:227], v[226:227]
    v_pk_mul_f32 v[8:9], v[228:229], v[228:229]
    v_pk_mul_f32 v[10:11], v[230:231], v[230:231]
    v_pk_fma_f32 v[4:5], v[4:5], s[4:5], v[172:173]
    v_pk_fma_f32 v[6:7], v[6:7], s[4:5], v[172:173]
    v_pk_fma_f32 v[8:9], v[8:9], s[4:5], v[172:173]
    v_pk_fma_f32 v[10:11], v[10:11], s[4:5], v[172:173]
    v_pk_mul_f32 v[4:5], v[4:5], v[224:225]
    v_pk_mul_f32 v[6:7], v[6:7], v[226:227]
    v_pk_mul_f32 v[8:9], v[8:9], v[228:229]
    v_pk_mul_f32 v[10:11], v[10:11], v[230:231]
    s_waitcnt vmcnt(12)
    s_barrier
    s_cmp_lg_u32 s48, 0
    s_cbranch_scc1 L_noep_7
    s_mov_b32 exec_hi, 0
    buffer_store_dword v51, v52, s[44:47], s96 offen sc1
    s_mov_b64 exec, -1
L_noep_7:
    s_add_u32 s96, s96, s3
    s_add_u32 m0, s53, 0
    s_add_u32 s56, s98, 655360
    buffer_load_dwordx4 v36, s[28:31], s56 offen offset:0 lds
    v_exp_f32 v4, v4
    v_exp_f32 v5, v5
    v_exp_f32 v6, v6
    v_exp_f32 v7, v7
    v_exp_f32 v8, v8
    v_exp_f32 v9, v9
    v_exp_f32 v10, v10
    v_exp_f32 v11, v11
    v_pk_add_f32 v[4:5], v[4:5], 1.0 op_sel_hi:[1,0]
    v_pk_add_f32 v[6:7], v[6:7], 1.0 op_sel_hi:[1,0]
    v_pk_add_f32 v[8:9], v[8:9], 1.0 op_sel_hi:[1,0]
    v_pk_add_f32 v[10:11], v[10:11], 1.0 op_sel_hi:[1,0]
    v_rcp_f32 v4, v4
    v_rcp_f32 v5, v5
    buffer_load_dwordx4 v37, s[28:31], s56 offen offset:1024 lds
    v_rcp_f32 v6, v6
    v_rcp_f32 v7, v7
    v_rcp_f32 v8, v8
    v_rcp_f32 v9, v9
    v_rcp_f32 v10, v10
    v_rcp_f32 v11, v11
    v_pk_mul_f32 v[4:5], v[4:5], v[224:225]
    v_pk_mul_f32 v[6:7], v[6:7], v[226:227]
    v_pk_mul_f32 v[8:9], v[8:9], v[228:229]
    v_pk_mul_f32 v[10:11], v[10:11], v[230:231]
    v_cvt_pk_bf16_f32 v168, v4, v5
    v_cvt_pk_bf16_f32 v169, v6, v7
    v_cvt_pk_bf16_f32 v170, v8, v9
    v_cvt_pk_bf16_f32 v171, v10, v11
    buffer_store_dwordx4 v[168:171], v54, s[36:39], s62 offen sc1
    ds_read_b64_tr_b16 a[0:1], v180 offset:8192
    ds_read_b64_tr_b16 a[2:3], v180 offset:10240
    ds_read_b64_tr_b16 a[4:5], v181 offset:8192
    buffer_load_dwordx4 v38, s[28:31], s56 offen offset:2048 lds
    ds_read_b64_tr_b16 a[6:7], v181 offset:10240
    ds_read_b64_tr_b16 a[8:9], v182 offset:8192
    ds_read_b64_tr_b16 a[10:11], v182 offset:10240
    ds_read_b64_tr_b16 a[12:13], v183 offset:8192
    ds_read_b64_tr_b16 a[14:15], v183 offset:10240
    ds_read_b64_tr_b16 a[16:17], v180 offset:12288
    ds_read_b64_tr_b16 a[18:19], v180 offset:14336
    ds_read_b64_tr_b16 a[20:21], v181 offset:12288
    ds_read_b64_tr_b16 a[22:23], v181 offset:14336
    ds_read_b64_tr_b16 a[24:25], v182 offset:12288
    buffer_load_dwordx4 v39, s[28:31], s56 offen offset:3072 lds
    ds_read_b64_tr_b16 a[26:27], v182 offset:14336
    ds_read_b64_tr_b16 a[28:29], v183 offset:12288
    ds_read_b64_tr_b16 a[30:31], v183 offset:14336
    s_add_u32 m0, s53, 4096
    s_add_u32 s56, s98, 786432
    buffer_load_dwordx4 v36, s[28:31], s56 offen offset:0 lds
    buffer_load_dwordx4 v37, s[28:31], s56 offen offset:1024 lds
    s_waitcnt vmcnt(15)
    ds_read_b64_tr_b16 a[32:33], v180 offset:16384
    ds_read_b64_tr_b16 a[34:35], v180 offset:18432
    ds_read_b64_tr_b16 a[36:37], v181 offset:16384
    ds_read_b64_tr_b16 a[38:39], v181 offset:18432
    ds_read_b64_tr_b16 a[40:41], v182 offset:16384
    ds_read_b64_tr_b16 a[42:43], v182 offset:18432
    ds_read_b64_tr_b16 a[44:45], v183 offset:16384
    ds_read_b64_tr_b16 a[46:47], v183 offset:18432
    buffer_load_dwordx4 v38, s[28:31], s56 offen offset:2048 lds
    buffer_load_dwordx4 v39, s[28:31], s56 offen offset:3072 lds
    s_waitcnt lgkmcnt(14)
    s_add_u32 m0, s53, 8192
    s_add_u32 s56, s98, 917504
    buffer_load_dwordx4 v36, s[28:31], s56 offen offset:0 lds
    buffer_load_dwordx4 v37, s[28:31], s56 offen offset:1024 lds
    s_waitcnt vmcnt(15)
    ds_read_b64_tr_b16 a[48:49], v180 offset:20480
    ds_read_b64_tr_b16 a[50:51], v180 offset:22528
    ds_read_b64_tr_b16 a[52:53], v181 offset:20480
    ds_read_b64_tr_b16 a[54:55], v181 offset:22528
    ds_read_b64_tr_b16 a[56:57], v182 offset:20480
    ds_read_b64_tr_b16 a[58:59], v182 offset:22528
    ds_read_b64_tr_b16 a[60:61], v183 offset:20480
    ds_read_b64_tr_b16 a[62:63], v183 offset:22528
    buffer_load_dwordx4 v38, s[28:31], s56 offen offset:2048 lds
    s_waitcnt vmcnt(9)
    s_barrier
    s_cmp_lg_u32 s48, 0
    s_cbranch_scc1 L_noep_8
    s_mov_b32 exec_hi, 0
    buffer_store_dword v51, v52, s[44:47], s96 offen sc1
    s_mov_b64 exec, -1
L_noep_8:
    s_or_b32 s58, s2, s48
    s_cmp_lg_u32 s58, 0
    s_cbranch_scc1 L_noep_9
    s_mov_b32 s96, 0x10000
    s_mov_b64 exec, 0x1
    buffer_store_dword v51, v52, s[44:47], s96 offen sc1
    s_mov_b64 exec, -1
L_noep_9:
    buffer_load_dwordx4 v39, s[28:31], s56 offen offset:3072 lds
    s_waitcnt lgkmcnt(14)
    s_add_u32 m0, s53, 12288
    s_add_u32 s56, s98, 1048576
    buffer_load_dwordx4 v36, s[28:31], s56 offen offset:0 lds
    buffer_load_dwordx4 v37, s[28:31], s56 offen offset:1024 lds
    ds_read_b64_tr_b16 a[64:65], v180 offset:24576
    ds_read_b64_tr_b16 a[66:67], v180 offset:26624
    ds_read_b64_tr_b16 a[68:69], v181 offset:24576
    ds_read_b64_tr_b16 a[70:71], v181 offset:26624
    ds_read_b64_tr_b16 a[72:73], v182 offset:24576
    ds_read_b64_tr_b16 a[74:75], v182 offset:26624
    ds_read_b64_tr_b16 a[76:77], v183 offset:24576
    ds_read_b64_tr_b16 a[78:79], v183 offset:26624
    buffer_load_dwordx4 v38, s[28:31], s56 offen offset:2048 lds
    buffer_load_dwordx4 v39, s[28:31], s56 offen offset:3072 lds
    s_waitcnt lgkmcnt(14)
    s_add_u32 m0, s53, 16384
    s_add_u32 s56, s98, 1179648
    buffer_load_dwordx4 v36, s[28:31], s56 offen offset:0 lds
    buffer_load_dwordx4 v37, s[28:31], s56 offen offset:1024 lds
    s_waitcnt vmcnt(14)
    ds_read_b64_tr_b16 a[80:81], v180 offset:0
    ds_read_b64_tr_b16 a[82:83], v180 offset:2048
    ds_read_b64_tr_b16 a[84:85], v181 offset:0
    ds_read_b64_tr_b16 a[86:87], v181 offset:2048
    ds_read_b64_tr_b16 a[88:89], v182 offset:0
    ds_read_b64_tr_b16 a[90:91], v182 offset:2048
    ds_read_b64_tr_b16 a[92:93], v183 offset:0
    ds_read_b64_tr_b16 a[94:95], v183 offset:2048
    buffer_load_dwordx4 v38, s[28:31], s56 offen offset:2048 lds
    buffer_load_dwordx4 v39, s[28:31], s56 offen offset:3072 lds
    s_waitcnt lgkmcnt(14)
    s_add_u32 m0, s53, 20480
    s_add_u32 s56, s98, 1310720
    buffer_load_dwordx4 v36, s[28:31], s56 offen offset:0 lds
    buffer_load_dwordx4 v37, s[28:31], s56 offen offset:1024 lds
    s_waitcnt vmcnt(14)
    ds_read_b64_tr_b16 a[96:97], v180 offset:4096
    ds_read_b64_tr_b16 a[98:99], v180 offset:6144
    ds_read_b64_tr_b16 a[100:101], v181 offset:4096
    ds_read_b64_tr_b16 a[102:103], v181 offset:6144
    ds_read_b64_tr_b16 a[104:105], v182 offset:4096
    ds_read_b64_tr_b16 a[106:107], v182 offset:6144
    ds_read_b64_tr_b16 a[108:109], v183 offset:4096
    ds_read_b64_tr_b16 a[110:111], v183 offset:6144
    buffer_load_dwordx4 v38, s[28:31], s56 offen offset:2048 lds
    buffer_load_dword v48, v50, s[44:47], 0 offen sc1
    buffer_load_dwordx4 v39, s[28:31], s56 offen offset:3072 lds
    s_waitcnt lgkmcnt(14)
    s_add_u32 m0, s53, 24576
    s_add_u32 s56, s98, 1441792
    buffer_load_dwordx4 v36, s[28:31], s56 offen offset:0 lds
    s_waitcnt vmcnt(14)
    ds_read_b64_tr_b16 a[112:113], v180 offset:8192
    ds_read_b64_tr_b16 a[114:115], v180 offset:10240
    ds_read_b64_tr_b16 a[116:117], v181 offset:8192
    ds_read_b64_tr_b16 a[118:119], v181 offset:10240
    ds_read_b64_tr_b16 a[120:121], v182 offset:8192
    ds_read_b64_tr_b16 a[122:123], v182 offset:10240
    ds_read_b64_tr_b16 a[124:125], v183 offset:8192
    ds_read_b64_tr_b16 a[126:127], v183 offset:10240
    buffer_load_dwordx4 v37, s[28:31], s56 offen offset:1024 lds
    buffer_load_dwordx4 v38, s[28:31], s56 offen offset:2048 lds
    buffer_load_dwordx4 v39, s[28:31], s56 offen offset:3072 lds
    s_waitcnt lgkmcnt(14)
    s_add_u32 m0, s53, 0
    s_add_u32 s56, s98, 1572864
    buffer_load_dwordx4 v36, s[28:31], s56 offen offset:0 lds
    s_waitcnt vmcnt(14)
    ds_read_b64_tr_b16 a[128:129], v180 offset:12288
    ds_read_b64_tr_b16 a[130:131], v180 offset:14336
    ds_read_b64_tr_b16 a[132:133], v181 offset:12288
    ds_read_b64_tr_b16 a[134:135], v181 offset:14336
    ds_read_b64_tr_b16 a[136:137], v182 offset:12288
    ds_read_b64_tr_b16 a[138:139], v182 offset:14336
    ds_read_b64_tr_b16 a[140:141], v183 offset:12288
    ds_read_b64_tr_b16 a[142:143], v183 offset:14336
    buffer_load_dwordx4 v37, s[28:31], s56 offen offset:1024 lds
    buffer_load_dwordx4 v38, s[28:31], s56 offen offset:2048 lds
    buffer_load_dwordx4 v39, s[28:31], s56 offen offset:3072 lds
    s_waitcnt lgkmcnt(14)
    s_add_u32 m0, s53, 4096
    s_add_u32 s56, s98, 1703936
    buffer_load_dwordx4 v36, s[28:31], s56 offen offset:0 lds
    s_waitcnt vmcnt(14)
    ds_read_b64_tr_b16 a[144:145], v180 offset:16384
    ds_read_b64_tr_b16 a[146:147], v180 offset:18432
    ds_read_b64_tr_b16 a[148:149], v181 offset:16384
    ds_read_b64_tr_b16 a[150:151], v181 offset:18432
    ds_read_b64_tr_b16 a[152:153], v182 offset:16384
    ds_read_b64_tr_b16 a[154:155], v182 offset:18432
    ds_read_b64_tr_b16 a[156:157], v183 offset:16384
    ds_read_b64_tr_b16 a[158:159], v183 offset:18432
    buffer_load_dwordx4 v37, s[28:31], s56 offen offset:1024 lds
    buffer_load_dwordx4 v38, s[28:31], s56 offen offset:2048 lds
    buffer_load_dwordx4 v39, s[28:31], s56 offen offset:3072 lds
    s_waitcnt vmcnt(13)
    v_cmp_ne_u32 vcc, s54, v48
    s_cbranch_vccz L_ok_10
    s_mov_b32 s59, 200000
L_spin_11:
    s_sleep 2
    buffer_load_dword v48, v50, s[44:47], 0 offen sc1
    s_sub_u32 s59, s59, 1
    s_cbranch_scc1 L_ok_10
    s_waitcnt vmcnt(0)
    v_cmp_ne_u32 vcc, s54, v48
    s_cbranch_vccnz L_spin_11
L_ok_10:
    s_barrier
    buffer_load_dwordx4 v[64:67], v56, s[36:39], s16 offen offset:0 sc1
    buffer_load_dwordx4 v[68:71], v56, s[36:39], s16 offen offset:1024 sc1
    s_waitcnt vmcnt(14)
    ds_read_b64_tr_b16 a[160:161], v180 offset:20480
    ds_read_b64_tr_b16 a[162:163], v180 offset:22528
    ds_read_b64_tr_b16 a[164:165], v181 offset:20480
    ds_read_b64_tr_b16 a[166:167], v181 offset:22528
    ds_read_b64_tr_b16 a[168:169], v182 offset:20480
    ds_read_b64_tr_b16 a[170:171], v182 offset:22528
    ds_read_b64_tr_b16 a[172:173], v183 offset:20480
    ds_read_b64_tr_b16 a[174:175], v183 offset:22528
    buffer_load_dwordx4 v[72:75], v57, s[36:39], s16 offen offset:0 sc1
    buffer_load_dwordx4 v[76:79], v57, s[36:39], s16 offen offset:1024 sc1
    buffer_load_dwordx4 v[80:83], v56, s[36:39], s16 offen offset:2048 sc1
    buffer_load_dwordx4 v[84:87], v56, s[36:39], s16 offen offset:3072 sc1
    s_waitcnt vmcnt(14)
    ds_read_b64_tr_b16 a[176:177], v180 offset:24576
    ds_read_b64_tr_b16 a[178:179], v180 offset:26624
    ds_read_b64_tr_b16 a[180:181], v181 offset:24576
    ds_read_b64_tr_b16 a[182:183], v181 offset:26624
    ds_read_b64_tr_b16 a[184:185], v182 offset:24576
    ds_read_b64_tr_b16 a[186:187], v182 offset:26624
    ds_read_b64_tr_b16 a[188:189], v183 offset:24576
    ds_read_b64_tr_b16 a[190:191], v183 offset:26624
    buffer_load_dwordx4 v[88:91], v57, s[36:39], s16 offen offset:2048 sc1
    buffer_load_dwordx4 v[92:95], v57, s[36:39], s16 offen offset:3072 sc1
    buffer_load_dwordx4 v[96:99], v56, s[36:39], s17 offen offset:0 sc1
    buffer_load_dwordx4 v[100:103], v56, s[36:39], s17 offen offset:1024 sc1
    s_waitcnt vmcnt(14)
    ds_read_b64_tr_b16 a[192:193], v180 offset:0
    ds_read_b64_tr_b16 a[194:195], v180 offset:2048
    ds_read_b64_tr_b16 a[196:197], v181 offset:0
    ds_read_b64_tr_b16 a[198:199], v181 offset:2048
    ds_read_b64_tr_b16 a[200:201], v182 offset:0
    ds_read_b64_tr_b16 a[202:203], v182 offset:2048
    ds_read_b64_tr_b16 a[204:205], v183 offset:0
    ds_read_b64_tr_b16 a[206:207], v183 offset:2048
    buffer_load_dwordx4 v[104:107], v57, s[36:39], s17 offen offset:0 sc1
    buffer_load_dwordx4 v[108:111], v57, s[36:39], s17 offen offset:1024 sc1
    s_waitcnt vmcnt(11)
    v_mfma_f32_16x16x32_bf16 v[216:219], v[64:67], a[12:15], 0
    ds_read_b64_tr_b16 a[208:209], v180 offset:4096
    ds_read_b64_tr_b16 a[210:211], v180 offset:6144
    s_waitcnt vmcnt(10)
    v_mfma_f32_16x16x32_bf16 v[216:219], v[68:71], a[28:31], v[216:219]
    ds_read_b64_tr_b16 a[212:213], v181 offset:4096
    ds_read_b64_tr_b16 a[214:215], v181 offset:6144
    v_mfma_f32_16x16x32_bf16 v[208:211], v[64:67], a[8:11], 0
    ds_read_b64_tr_b16 a[216:217], v182 offset:4096
    ds_read_b64_tr_b16 a[218:219], v182 offset:6144
    v_mfma_f32_16x16x32_bf16 v[208:211], v[68:71], a[24:27], v[208:211]
    ds_read_b64_tr_b16 a[220:221], v183 offset:4096
    ds_read_b64_tr_b16 a[222:223], v183 offset:6144
    v_mfma_f32_16x16x32_bf16 v[200:203], v[64:67], a[4:7], 0
    buffer_load_dwordx4 v[112:115], v56, s[36:39], s17 offen offset:2048 sc1
    v_mfma_f32_16x16x32_bf16 v[200:203], v[68:71], a[20:23], v[200:203]
    v_mfma_f32_16x16x32_bf16 v[192:195], v[64:67], a[0:3], v[160:163]
    v_mfma_f32_16x16x32_bf16 v[192:195], v[68:71], a[16:19], v[192:195]
    buffer_load_dwordx4 v[116:119], v56, s[36:39], s17 offen offset:3072 sc1
    s_waitcnt vmcnt(11)
    v_mfma_f32_16x16x32_bf16 v[220:223], v[72:75], a[12:15], 0
    s_waitcnt vmcnt(10)
    v_mfma_f32_16x16x32_bf16 v[220:223], v[76:79], a[28:31], v[220:223]
    v_mfma_f32_16x16x32_bf16 v[212:215], v[72:75], a[8:11], 0
    v_mfma_f32_16x16x32_bf16 v[212:215], v[76:79], a[24:27], v[212:215]
    v_mfma_f32_16x16x32_bf16 v[204:207], v[72:75], a[4:7], 0
    buffer_load_dwordx4 v[120:123], v57, s[36:39], s17 offen offset:2048 sc1
    v_mfma_f32_16x16x32_bf16 v[204:207], v[76:79], a[20:23], v[204:207]
    v_mfma_f32_16x16x32_bf16 v[196:199], v[72:75], a[0:3], v[160:163]
    v_mfma_f32_16x16x32_bf16 v[196:199], v[76:79], a[16:19], v[196:199]
    buffer_load_dword v48, v50, s[44:47], s3 offen sc1
    s_waitcnt vmcnt(11)
    v_mfma_f32_16x16x32_bf16 v[216:219], v[80:83], a[44:47], v[216:219]
    s_waitcnt vmcnt(10)
    v_mfma_f32_16x16x32_bf16 v[216:219], v[84:87], a[60:63], v[216:219]
    v_mfma_f32_16x16x32_bf16 v[208:211], v[80:83], a[40:43], v[208:211]
    v_mfma_f32_16x16x32_bf16 v[208:211], v[84:87], a[56:59], v[208:211]
    v_mfma_f32_16x16x32_bf16 v[200:203], v[80:83], a[36:39], v[200:203]
    buffer_load_dwordx4 v[124:127], v57, s[36:39], s17 offen offset:3072 sc1
    v_mfma_f32_16x16x32_bf16 v[200:203], v[84:87], a[52:55], v[200:203]
    v_mfma_f32_16x16x32_bf16 v[192:195], v[80:83], a[32:35], v[192:195]
    v_mfma_f32_16x16x32_bf16 v[192:195], v[84:87], a[48:51], v[192:195]
    buffer_load_dwordx4 v[64:67], v56, s[36:39], s18 offen offset:0 sc1
    s_waitcnt vmcnt(11)
    v_mfma_f32_16x16x32_bf16 v[220:223], v[88:91], a[44:47], v[220:223]
    s_waitcnt vmcnt(10)
    v_mfma_f32_16x16x32_bf16 v[220:223], v[92:95], a[60:63], v[220:223]
    v_mfma_f32_16x16x32_bf16 v[212:215], v[88:91], a[40:43], v[212:215]
    v_mfma_f32_16x16x32_bf16 v[212:215], v[92:95], a[56:59], v[212:215]
    v_mfma_f32_16x16x32_bf16 v[204:207], v[88:91], a[36:39], v[204:207]
    buffer_load_dwordx4 v[68:71], v56, s[36:39], s18 offen offset:1024 sc1
    v_mfma_f32_16x16x32_bf16 v[204:207], v[92:95], a[52:55], v[204:207]
    v_mfma_f32_16x16x32_bf16 v[196:199], v[88:91], a[32:35], v[196:199]
    v_mfma_f32_16x16x32_bf16 v[196:199], v[92:95], a[48:51], v[196:199]
    buffer_load_dwordx4 v[72:75], v57, s[36:39], s18 offen offset:0 sc1
    s_waitcnt vmcnt(11)
    v_mfma_f32_16x16x32_bf16 v[216:219], v[96:99], a[76:79], v[216:219]
    s_waitcnt vmcnt(10)
    v_mfma_f32_16x16x32_bf16 v[216:219], v[100:103], a[92:95], v[216:219]
    v_mfma_f32_16x16x32_bf16 v[208:211], v[96:99], a[72:75], v[208:211]
    v_mfma_f32_16x16x32_bf16 v[208:211], v[100:103], a[88:91], v[208:211]
    v_mfma_f32_16x16x32_bf16 v[200:203], v[96:99], a[68:71], v[200:203]
    buffer_load_dwordx4 v[76:79], v57, s[36:39], s18 offen offset:1024 sc1
    v_mfma_f32_16x16x32_bf16 v[200:203], v[100:103], a[84:87], v[200:203]
    v_mfma_f32_16x16x32_bf16 v[192:195], v[96:99], a[64:67], v[192:195]
    v_mfma_f32_16x16x32_bf16 v[192:195], v[100:103], a[80:83], v[192:195]
    buffer_load_dwordx4 v[80:83], v56, s[36:39], s18 offen offset:2048 sc1
    s_waitcnt vmcnt(11)
    v_mfma_f32_16x16x32_bf16 v[220:223], v[104:107], a[76:79], v[220:223]
    s_waitcnt vmcnt(10)
    v_mfma_f32_16x16x32_bf16 v[220:223], v[108:111], a[92:95], v[220:223]
    v_mfma_f32_16x16x32_bf16 v[212:215], v[104:107], a[72:75], v[212:215]
    v_mfma_f32_16x16x32_bf16 v[212:215], v[108:111], a[88:91], v[212:215]
    v_mfma_f32_16x16x32_bf16 v[204:207], v[104:107], a[68:71], v[204:207]
    buffer_load_dwordx4 v[84:87], v56, s[36:39], s18 offen offset:3072 sc1
    v_mfma_f32_16x16x32_bf16 v[204:207], v[108:111], a[84:87], v[204:207]
    v_mfma_f32_16x16x32_bf16 v[196:199], v[104:107], a[64:67], v[196:199]
    v_mfma_f32_16x16x32_bf16 v[196:199], v[108:111], a[80:83], v[196:199]
    buffer_load_dwordx4 v[88:91], v57, s[36:39], s18 offen offset:2048 sc1
    s_waitcnt vmcnt(11) lgkmcnt(14)
    v_mfma_f32_16x16x32_bf16 v[216:219], v[112:115], a[108:111], v[216:219]
    s_waitcnt vmcnt(10)
    v_mfma_f32_16x16x32_bf16 v[216:219], v[116:119], a[124:127], v[216:219]
    v_mfma_f32_16x16x32_bf16 v[208:211], v[112:115], a[104:107], v[208:211]
    v_mfma_f32_16x16x32_bf16 v[208:211], v[116:119], a[120:123], v[208:211]
    v_mfma_f32_16x16x32_bf16 v[200:203], v[112:115], a[100:103], v[200:203]
    buffer_load_dwordx4 v[92:95], v57, s[36:39], s18 offen offset:3072 sc1
    v_mfma_f32_16x16x32_bf16 v[200:203], v[116:119], a[116:119], v[200:203]
    v_mfma_f32_16x16x32_bf16 v[192:195], v[112:115], a[96:99], v[192:195]
    v_mfma_f32_16x16x32_bf16 v[192:195], v[116:119], a[112:115], v[192:195]
    buffer_load_dwordx4 v[96:99], v56, s[36:39], s19 offen offset:0 sc1
    s_waitcnt vmcnt(11)
    v_mfma_f32_16x16x32_bf16 v[220:223], v[120:123], a[108:111], v[220:223]
    s_waitcnt vmcnt(9)
    v_mfma_f32_16x16x32_bf16 v[220:223], v[124:127], a[124:127], v[220:223]
    v_mfma_f32_16x16x32_bf16 v[212:215], v[120:123], a[104:107], v[212:215]
    v_mfma_f32_16x16x32_bf16 v[212:215], v[124:127], a[120:123], v[212:215]
    v_mfma_f32_16x16x32_bf16 v[204:207], v[120:123], a[100:103], v[204:207]
    buffer_load_dwordx4 v[100:103], v56, s[36:39], s19 offen offset:1024 sc1
    v_mfma_f32_16x16x32_bf16 v[204:207], v[124:127], a[116:119], v[204:207]
    v_mfma_f32_16x16x32_bf16 v[196:199], v[120:123], a[96:99], v[196:199]
    v_mfma_f32_16x16x32_bf16 v[196:199], v[124:127], a[112:115], v[196:199]
    buffer_load_dwordx4 v[104:107], v57, s[36:39], s19 offen offset:0 sc1
    buffer_load_dwordx4 v[108:111], v57, s[36:39], s19 offen offset:1024 sc1
    s_waitcnt vmcnt(11)
    v_mfma_f32_16x16x32_bf16 v[216:219], v[64:67], a[140:143], v[216:219]
    s_waitcnt vmcnt(10)
    v_mfma_f32_16x16x32_bf16 v[216:219], v[68:71], a[156:159], v[216:219]
    v_mfma_f32_16x16x32_bf16 v[208:211], v[64:67], a[136:139], v[208:211]
    v_mfma_f32_16x16x32_bf16 v[208:211], v[68:71], a[152:155], v[208:211]
    v_mfma_f32_16x16x32_bf16 v[200:203], v[64:67], a[132:135], v[200:203]
    v_cmp_ne_u32 vcc, s54, v48
    s_cbranch_vccz L_ok_12
    s_mov_b32 s59, 200000
L_spin_13:
    s_sleep 2
    buffer_load_dword v48, v50, s[44:47], s3 offen sc1
    s_sub_u32 s59, s59, 1
    s_cbranch_scc1 L_ok_12
    s_waitcnt vmcnt(0)
    v_cmp_ne_u32 vcc, s54, v48
    s_cbranch_vccnz L_spin_13
L_ok_12:
    buffer_load_dwordx4 v[112:115], v185, s[36:39], s16 offen offset:0 sc1
    v_mfma_f32_16x16x32_bf16 v[200:203], v[68:71], a[148:151], v[200:203]
    v_mfma_f32_16x16x32_bf16 v[192:195], v[64:67], a[128:131], v[192:195]
    v_mfma_f32_16x16x32_bf16 v[192:195], v[68:71], a[144:147], v[192:195]
    buffer_load_dwordx4 v[116:119], v185, s[36:39], s16 offen offset:1024 sc1
    s_waitcnt vmcnt(11)
    v_mfma_f32_16x16x32_bf16 v[220:223], v[72:75], a[140:143], v[220:223]
    s_waitcnt vmcnt(10)
    v_mfma_f32_16x16x32_bf16 v[220:223], v[76:79], a[156:159], v[220:223]
    v_mfma_f32_16x16x32_bf16 v[212:215], v[72:75], a[136:139], v[212:215]
    v_mfma_f32_16x16x32_bf16 v[212:215], v[76:79], a[152:155], v[212:215]
    v_mfma_f32_16x16x32_bf16 v[204:207], v[72:75], a[132:135], v[204:207]
    buffer_load_dwordx4 v[120:123], v185, s[36:39], s16 offen offset:2048 sc1
    v_mfma_f32_16x16x32_bf16 v[204:207], v[76:79], a[148:151], v[204:207]
    v_mfma_f32_16x16x32_bf16 v[196:199], v[72:75], a[128:131], v[196:199]
    v_mfma_f32_16x16x32_bf16 v[196:199], v[76:79], a[144:147], v[196:199]
    buffer_load_dwordx4 v[124:127], v185, s[36:39], s16 offen offset:3072 sc1
    s_waitcnt vmcnt(11)
    v_mfma_f32_16x16x32_bf16 v[216:219], v[80:83], a[172:175], v[216:219]
    s_waitcnt vmcnt(10)
    v_mfma_f32_16x16x32_bf16 v[216:219], v[84:87], a[188:191], v[216:219]
    v_mfma_f32_16x16x32_bf16 v[208:211], v[80:83], a[168:171], v[208:211]
    v_mfma_f32_16x16x32_bf16 v[208:211], v[84:87], a[184:187], v[208:211]
    v_mfma_f32_16x16x32_bf16 v[200:203], v[80:83], a[164:167], v[200:203]
    buffer_load_dwordx4 v[64:67], v185, s[36:39], s17 offen offset:0 sc1
    v_mfma_f32_16x16x32_bf16 v[200:203], v[84:87], a[180:183], v[200:203]
    v_mfma_f32_16x16x32_bf16 v[192:195], v[80:83], a[160:163], v[192:195]
    v_mfma_f32_16x16x32_bf16 v[192:195], v[84:87], a[176:179], v[192:195]
    buffer_load_dwordx4 v[68:71], v185, s[36:39], s17 offen offset:1024 sc1
    s_waitcnt vmcnt(11)
    v_mfma_f32_16x16x32_bf16 v[220:223], v[88:91], a[172:175], v[220:223]
    s_waitcnt vmcnt(10)
    v_mfma_f32_16x16x32_bf16 v[220:223], v[92:95], a[188:191], v[220:223]
    v_mfma_f32_16x16x32_bf16 v[212:215], v[88:91], a[168:171], v[212:215]
    v_mfma_f32_16x16x32_bf16 v[212:215], v[92:95], a[184:187], v[212:215]
    v_mfma_f32_16x16x32_bf16 v[204:207], v[88:91], a[164:167], v[204:207]
    buffer_load_dwordx4 v[72:75], v185, s[36:39], s17 offen offset:2048 sc1
    v_mfma_f32_16x16x32_bf16 v[204:207], v[92:95], a[180:183], v[204:207]
    v_mfma_f32_16x16x32_bf16 v[196:199], v[88:91], a[160:163], v[196:199]
    v_mfma_f32_16x16x32_bf16 v[196:199], v[92:95], a[176:179], v[196:199]
    buffer_load_dwordx4 v[76:79], v185, s[36:39], s17 offen offset:3072 sc1
    s_waitcnt vmcnt(11) lgkmcnt(0)
    v_mfma_f32_16x16x32_bf16 v[216:219], v[96:99], a[204:207], v[216:219]
    s_waitcnt vmcnt(10)
    v_mfma_f32_16x16x32_bf16 v[216:219], v[100:103], a[220:223], v[216:219]
    v_mfma_f32_16x16x32_bf16 v[208:211], v[96:99], a[200:203], v[208:211]
    v_mfma_f32_16x16x32_bf16 v[208:211], v[100:103], a[216:219], v[208:211]
    v_mfma_f32_16x16x32_bf16 v[200:203], v[96:99], a[196:199], v[200:203]
    buffer_load_dwordx4 v[80:83], v185, s[36:39], s18 offen offset:0 sc1
    v_mfma_f32_16x16x32_bf16 v[200:203], v[100:103], a[212:215], v[200:203]
    v_mfma_f32_16x16x32_bf16 v[192:195], v[96:99], a[192:195], v[192:195]
    v_mfma_f32_16x16x32_bf16 v[192:195], v[100:103], a[208:211], v[192:195]
    buffer_load_dwordx4 v[84:87], v185, s[36:39], s18 offen offset:1024 sc1
    s_waitcnt vmcnt(11)
    v_mfma_f32_16x16x32_bf16 v[220:223], v[104:107], a[204:207], v[220:223]
    s_waitcnt vmcnt(10)
    v_mfma_f32_16x16x32_bf16 v[220:223], v[108:111], a[220:223], v[220:223]
    v_mfma_f32_16x16x32_bf16 v[212:215], v[104:107], a[200:203], v[212:215]
    v_mfma_f32_16x16x32_bf16 v[212:215], v[108:111], a[216:219], v[212:215]
    v_mfma_f32_16x16x32_bf16 v[204:207], v[104:107], a[196:199], v[204:207]
    buffer_load_dwordx4 v[88:91], v185, s[36:39], s18 offen offset:2048 sc1
    v_mfma_f32_16x16x32_bf16 v[204:207], v[108:111], a[212:215], v[204:207]
    v_mfma_f32_16x16x32_bf16 v[196:199], v[104:107], a[192:195], v[196:199]
    v_mfma_f32_16x16x32_bf16 v[196:199], v[108:111], a[208:211], v[196:199]
    buffer_load_dwordx4 v[92:95], v185, s[36:39], s18 offen offset:3072 sc1
    s_waitcnt vmcnt(11)
    v_mfma_f32_16x16x32_bf16 v[252:255], v[112:115], a[12:15], 0
    s_waitcnt vmcnt(10)
    v_mfma_f32_16x16x32_bf16 v[252:255], v[116:119], a[28:31], v[252:255]
    v_mfma_f32_16x16x32_bf16 v[244:247], v[112:115], a[8:11], 0
    v_mfma_f32_16x16x32_bf16 v[244:247], v[116:119], a[24:27], v[244:247]
    v_mfma_f32_16x16x32_bf16 v[236:239], v[112:115], a[4:7], 0
    buffer_load_dwordx4 v[96:99], v185, s[36:39], s19 offen offset:0 sc1
    v_mfma_f32_16x16x32_bf16 v[236:239], v[116:119], a[20:23], v[236:239]
    ds_write_b128 v45, v[216:219] offset:0
    v_mfma_f32_16x16x32_bf16 v[228:231], v[112:115], a[0:3], v[160:163]
    v_mfma_f32_16x16x32_bf16 v[228:231], v[116:119], a[16:19], v[228:231]
    buffer_load_dwordx4 v[100:103], v185, s[36:39], s19 offen offset:1024 sc1
    s_waitcnt vmcnt(11)
    v_mfma_f32_16x16x32_bf16 v[252:255], v[120:123], a[44:47], v[252:255]
    ds_write_b128 v45, v[220:223] offset:1024
    s_waitcnt vmcnt(10)
    v_mfma_f32_16x16x32_bf16 v[252:255], v[124:127], a[60:63], v[252:255]
    v_mfma_f32_16x16x32_bf16 v[244:247], v[120:123], a[40:43], v[244:247]
    v_mfma_f32_16x16x32_bf16 v[244:247], v[124:127], a[56:59], v[244:247]
    v_mfma_f32_16x16x32_bf16 v[236:239], v[120:123], a[36:39], v[236:239]
    buffer_load_dwordx4 v[104:107], v184, s[36:39], s16 offen offset:0 sc1
    v_mfma_f32_16x16x32_bf16 v[236:239], v[124:127], a[52:55], v[236:239]
    ds_write_b128 v44, v[208:211] offset:0
    v_mfma_f32_16x16x32_bf16 v[228:231], v[120:123], a[32:35], v[228:231]
    v_mfma_f32_16x16x32_bf16 v[228:231], v[124:127], a[48:51], v[228:231]
    buffer_load_dwordx4 v[108:111], v184, s[36:39], s16 offen offset:1024 sc1
    s_waitcnt vmcnt(11)
    v_mfma_f32_16x16x32_bf16 v[252:255], v[64:67], a[76:79], v[252:255]
    ds_write_b128 v44, v[212:215] offset:1024
    s_waitcnt vmcnt(10)
    v_mfma_f32_16x16x32_bf16 v[252:255], v[68:71], a[92:95], v[252:255]
    v_mfma_f32_16x16x32_bf16 v[244:247], v[64:67], a[72:75], v[244:247]
    v_mfma_f32_16x16x32_bf16 v[244:247], v[68:71], a[88:91], v[244:247]
    v_mfma_f32_16x16x32_bf16 v[236:239], v[64:67], a[68:71], v[236:239]
    buffer_load_dwordx4 v[112:115], v184, s[36:39], s16 offen offset:2048 sc1
    v_mfma_f32_16x16x32_bf16 v[236:239], v[68:71], a[84:87], v[236:239]
    ds_write_b128 v43, v[200:203] offset:0
    v_mfma_f32_16x16x32_bf16 v[228:231], v[64:67], a[64:67], v[228:231]
    v_mfma_f32_16x16x32_bf16 v[228:231], v[68:71], a[80:83], v[228:231]
    buffer_load_dwordx4 v[116:119], v184, s[36:39], s16 offen offset:3072 sc1
    s_waitcnt vmcnt(11)
    v_mfma_f32_16x16x32_bf16 v[252:255], v[72:75], a[108:111], v[252:255]
    ds_write_b128 v43, v[204:207] offset:1024
    s_waitcnt vmcnt(10)
    v_mfma_f32_16x16x32_bf16 v[252:255], v[76:79], a[124:127], v[252:255]
    v_mfma_f32_16x16x32_bf16 v[244:247], v[72:75], a[104:107], v[244:247]
    v_mfma_f32_16x16x32_bf16 v[244:247], v[76:79], a[120:123], v[244:247]
    v_mfma_f32_16x16x32_bf16 v[236:239], v[72:75], a[100:103], v[236:239]
    buffer_load_dwordx4 v[120:123], v184, s[36:39], s17 offen offset:0 sc1
    v_mfma_f32_16x16x32_bf16 v[236:239], v[76:79], a[116:119], v[236:239]
    v_mfma_f32_16x16x32_bf16 v[228:231], v[72:75], a[96:99], v[228:231]
    v_mfma_f32_16x16x32_bf16 v[228:231], v[76:79], a[112:115], v[228:231]
    buffer_load_dwordx4 v[124:127], v184, s[36:39], s17 offen offset:1024 sc1
    s_waitcnt vmcnt(11)
    v_mfma_f32_16x16x32_bf16 v[252:255], v[80:83], a[140:143], v[252:255]
    s_waitcnt lgkmcnt(0)
    s_barrier
    s_waitcnt vmcnt(10)
    v_mfma_f32_16x16x32_bf16 v[252:255], v[84:87], a[156:159], v[252:255]
    ds_read_b128 v[128:131], v46 offset:0
    ds_read_b128 v[132:135], v46 offset:1024
    v_mfma_f32_16x16x32_bf16 v[244:247], v[80:83], a[136:139], v[244:247]
    ds_read_b128 v[136:139], v46 offset:2048
    ds_read_b128 v[140:143], v46 offset:3072
    v_mfma_f32_16x16x32_bf16 v[244:247], v[84:87], a[152:155], v[244:247]
    ds_read_b128 v[144:147], v46 offset:4096
    ds_read_b128 v[148:151], v46 offset:5120
    v_mfma_f32_16x16x32_bf16 v[236:239], v[80:83], a[132:135], v[236:239]
    buffer_load_dwordx4 v[64:67], v184, s[36:39], s17 offen offset:2048 sc1
    v_mfma_f32_16x16x32_bf16 v[236:239], v[84:87], a[148:151], v[236:239]
    v_mfma_f32_16x16x32_bf16 v[228:231], v[80:83], a[128:131], v[228:231]
    v_mfma_f32_16x16x32_bf16 v[228:231], v[84:87], a[144:147], v[228:231]
    buffer_load_dwordx4 v[68:71], v184, s[36:39], s17 offen offset:3072 sc1
    s_waitcnt vmcnt(11)
    v_mfma_f32_16x16x32_bf16 v[252:255], v[88:91], a[172:175], v[252:255]
    s_waitcnt lgkmcnt(4)
    v_add_f32 v192, v192, v128
    v_add_f32 v193, v193, v129
    s_waitcnt vmcnt(10)
    v_mfma_f32_16x16x32_bf16 v[252:255], v[92:95], a[188:191], v[252:255]
    v_add_f32 v194, v194, v130
    v_add_f32 v195, v195, v131
    v_mfma_f32_16x16x32_bf16 v[244:247], v[88:91], a[168:171], v[244:247]
    v_add_f32 v196, v196, v132
    v_add_f32 v197, v197, v133
    v_mfma_f32_16x16x32_bf16 v[244:247], v[92:95], a[184:187], v[244:247]
    v_add_f32 v198, v198, v134
    v_add_f32 v199, v199, v135
    v_mfma_f32_16x16x32_bf16 v[236:239], v[88:91], a[164:167], v[236:239]
    buffer_load_dwordx4 v[72:75], v184, s[36:39], s18 offen offset:0 sc1
    v_mfma_f32_16x16x32_bf16 v[236:239], v[92:95], a[180:183], v[236:239]
    s_waitcnt lgkmcnt(2)
    v_add_f32 v192, v192, v136
    v_add_f32 v193, v193, v137
    v_mfma_f32_16x16x32_bf16 v[228:231], v[88:91], a[160:163], v[228:231]
    v_add_f32 v194, v194, v138
    v_add_f32 v195, v195, v139
    v_mfma_f32_16x16x32_bf16 v[228:231], v[92:95], a[176:179], v[228:231]
    buffer_load_dwordx4 v[76:79], v184, s[36:39], s18 offen offset:1024 sc1
    s_waitcnt vmcnt(11)
    v_mfma_f32_16x16x32_bf16 v[252:255], v[96:99], a[204:207], v[252:255]
    v_add_f32 v196, v196, v140
    v_add_f32 v197, v197, v141
    s_waitcnt vmcnt(10)
    v_mfma_f32_16x16x32_bf16 v[252:255], v[100:103], a[220:223], v[252:255]
    v_add_f32 v198, v198, v142
    v_add_f32 v199, v199, v143
    v_mfma_f32_16x16x32_bf16 v[244:247], v[96:99], a[200:203], v[244:247]
    s_waitcnt lgkmcnt(0)
    v_add_f32 v192, v192, v144
    v_add_f32 v193, v193, v145
    v_mfma_f32_16x16x32_bf16 v[244:247], v[100:103], a[216:219], v[244:247]
    v_add_f32 v194, v194, v146
    v_add_f32 v195, v195, v147
    v_mfma_f32_16x16x32_bf16 v[236:239], v[96:99], a[196:199], v[236:239]
    buffer_load_dwordx4 v[80:83], v184, s[36:39], s18 offen offset:2048 sc1
    v_mfma_f32_16x16x32_bf16 v[236:239], v[100:103], a[212:215], v[236:239]
    v_add_f32 v196, v196, v148
    v_add_f32 v197, v197, v149
    v_mfma_f32_16x16x32_bf16 v[228:231], v[96:99], a[192:195], v[228:231]
    v_add_f32 v198, v198, v150
    v_add_f32 v199, v199, v151
    v_mfma_f32_16x16x32_bf16 v[228:231], v[100:103], a[208:211], v[228:231]
    buffer_load_dwordx4 v[84:87], v184, s[36:39], s18 offen offset:3072 sc1
    s_waitcnt vmcnt(11)
    v_mfma_f32_16x16x32_bf16 v[248:251], v[104:107], a[12:15], 0
    v_cvt_pk_bf16_f32 v164, v192, v193
    v_cvt_pk_bf16_f32 v165, v194, v195
    s_waitcnt vmcnt(10)
    v_mfma_f32_16x16x32_bf16 v[248:251], v[108:111], a[28:31], v[248:251]
    v_cvt_pk_bf16_f32 v166, v196, v197
    v_cvt_pk_bf16_f32 v167, v198, v199
    v_mfma_f32_16x16x32_bf16 v[240:243], v[104:107], a[8:11], 0
    v_mfma_f32_16x16x32_bf16 v[240:243], v[108:111], a[24:27], v[240:243]
    v_mfma_f32_16x16x32_bf16 v[232:235], v[104:107], a[4:7], 0
    buffer_load_dwordx4 v[88:91], v184, s[36:39], s19 offen offset:0 sc1
    v_mfma_f32_16x16x32_bf16 v[232:235], v[108:111], a[20:23], v[232:235]
    ds_write_b128 v45, v[252:255] offset:25600
    v_mfma_f32_16x16x32_bf16 v[224:227], v[104:107], a[0:3], v[160:163]
    v_mfma_f32_16x16x32_bf16 v[224:227], v[108:111], a[16:19], v[224:227]
    buffer_load_dwordx4 v[92:95], v184, s[36:39], s19 offen offset:1024 sc1
    s_waitcnt vmcnt(11)
    v_mfma_f32_16x16x32_bf16 v[248:251], v[112:115], a[44:47], v[248:251]
    s_waitcnt vmcnt(10)
    v_mfma_f32_16x16x32_bf16 v[248:251], v[116:119], a[60:63], v[248:251]
    ds_write_b128 v44, v[244:247] offset:25600
    v_mfma_f32_16x16x32_bf16 v[240:243], v[112:115], a[40:43], v[240:243]
    v_mfma_f32_16x16x32_bf16 v[240:243], v[116:119], a[56:59], v[240:243]
    v_mfma_f32_16x16x32_bf16 v[232:235], v[112:115], a[36:39], v[232:235]
    v_mfma_f32_16x16x32_bf16 v[232:235], v[116:119], a[52:55], v[232:235]
    ds_write_b128 v43, v[236:239] offset:25600
    v_mfma_f32_16x16x32_bf16 v[224:227], v[112:115], a[32:35], v[224:227]
    v_mfma_f32_16x16x32_bf16 v[224:227], v[116:119], a[48:51], v[224:227]
    s_waitcnt vmcnt(9)
    v_mfma_f32_16x16x32_bf16 v[248:251], v[120:123], a[76:79], v[248:251]
    s_waitcnt vmcnt(8)
    v_mfma_f32_16x16x32_bf16 v[248:251], v[124:127], a[92:95], v[248:251]
    v_mfma_f32_16x16x32_bf16 v[240:243], v[120:123], a[72:75], v[240:243]
    v_mfma_f32_16x16x32_bf16 v[240:243], v[124:127], a[88:91], v[240:243]
    v_mfma_f32_16x16x32_bf16 v[232:235], v[120:123], a[68:71], v[232:235]
    v_mfma_f32_16x16x32_bf16 v[232:235], v[124:127], a[84:87], v[232:235]
    s_waitcnt lgkmcnt(0)
    s_barrier
    v_mfma_f32_16x16x32_bf16 v[224:227], v[120:123], a[64:67], v[224:227]
    ds_read_b128 v[132:135], v46 offset:25600
    ds_read_b128 v[140:143], v46 offset:27648
    v_mfma_f32_16x16x32_bf16 v[224:227], v[124:127], a[80:83], v[224:227]
    s_waitcnt vmcnt(7)
    v_mfma_f32_16x16x32_bf16 v[248:251], v[64:67], a[108:111], v[248:251]
    ds_read_b128 v[148:151], v46 offset:29696
    s_waitcnt vmcnt(6)
    v_mfma_f32_16x16x32_bf16 v[248:251], v[68:71], a[124:127], v[248:251]
    v_mfma_f32_16x16x32_bf16 v[240:243], v[64:67], a[104:107], v[240:243]
    v_mfma_f32_16x16x32_bf16 v[240:243], v[68:71], a[120:123], v[240:243]
    v_mfma_f32_16x16x32_bf16 v[232:235], v[64:67], a[100:103], v[232:235]
    v_mfma_f32_16x16x32_bf16 v[232:235], v[68:71], a[116:119], v[232:235]
    v_mfma_f32_16x16x32_bf16 v[224:227], v[64:67], a[96:99], v[224:227]
    v_mfma_f32_16x16x32_bf16 v[224:227], v[68:71], a[112:115], v[224:227]
    s_waitcnt vmcnt(5)
    v_mfma_f32_16x16x32_bf16 v[248:251], v[72:75], a[140:143], v[248:251]
    s_waitcnt lgkmcnt(0)
    v_add_f32 v228, v228, v132
    v_add_f32 v229, v229, v133
    s_waitcnt vmcnt(4)
    v_mfma_f32_16x16x32_bf16 v[248:251], v[76:79], a[156:159], v[248:251]
    v_add_f32 v230, v230, v134
    v_add_f32 v231, v231, v135
    v_mfma_f32_16x16x32_bf16 v[240:243], v[72:75], a[136:139], v[240:243]
    v_add_f32 v228, v228, v140
    v_add_f32 v229, v229, v141
    v_mfma_f32_16x16x32_bf16 v[240:243], v[76:79], a[152:155], v[240:243]
    v_add_f32 v230, v230, v142
    v_add_f32 v231, v231, v143
    v_mfma_f32_16x16x32_bf16 v[232:235], v[72:75], a[132:135], v[232:235]
    v_mfma_f32_16x16x32_bf16 v[232:235], v[76:79], a[148:151], v[232:235]
    v_add_f32 v228, v228, v148
    v_add_f32 v229, v229, v149
    v_mfma_f32_16x16x32_bf16 v[224:227], v[72:75], a[128:131], v[224:227]
    v_add_f32 v230, v230, v150
    v_add_f32 v231, v231, v151
    v_mfma_f32_16x16x32_bf16 v[224:227], v[76:79], a[144:147], v[224:227]
    s_waitcnt vmcnt(3)
    v_mfma_f32_16x16x32_bf16 v[248:251], v[80:83], a[172:175], v[248:251]
    buffer_store_dwordx4 v[164:167], v47, s[40:43], s100 offen offset:0 sc1
    s_waitcnt vmcnt(3)
    v_mfma_f32_16x16x32_bf16 v[248:251], v[84:87], a[188:191], v[248:251]
    v_mfma_f32_16x16x32_bf16 v[240:243], v[80:83], a[168:171], v[240:243]
    v_mfma_f32_16x16x32_bf16 v[240:243], v[84:87], a[184:187], v[240:243]
    v_mfma_f32_16x16x32_bf16 v[232:235], v[80:83], a[164:167], v[232:235]
    v_mfma_f32_16x16x32_bf16 v[232:235], v[84:87], a[180:183], v[232:235]
    v_mfma_f32_16x16x32_bf16 v[224:227], v[80:83], a[160:163], v[224:227]
    v_mfma_f32_16x16x32_bf16 v[224:227], v[84:87], a[176:179], v[224:227]
    s_waitcnt vmcnt(2)
    v_mfma_f32_16x16x32_bf16 v[248:251], v[88:91], a[204:207], v[248:251]
    v_mfma_f32_16x16x32_bf16 v[240:243], v[88:91], a[200:203], v[240:243]
    v_mfma_f32_16x16x32_bf16 v[232:235], v[88:91], a[196:199], v[232:235]
    v_mfma_f32_16x16x32_bf16 v[224:227], v[88:91], a[192:195], v[224:227]
    s_waitcnt vmcnt(1)
    v_mfma_f32_16x16x32_bf16 v[248:251], v[92:95], a[220:223], v[248:251]
    v_mfma_f32_16x16x32_bf16 v[240:243], v[92:95], a[216:219], v[240:243]
    v_mfma_f32_16x16x32_bf16 v[232:235], v[92:95], a[212:215], v[232:235]
    v_mfma_f32_16x16x32_bf16 v[224:227], v[92:95], a[208:211], v[224:227]
    s_nop 7
    ds_write_b128 v45, v[248:251] offset:24576
    ds_write_b128 v44, v[240:243] offset:24576
    ds_write_b128 v43, v[232:235] offset:24576
    s_waitcnt lgkmcnt(0)
    s_barrier
    ds_read_b128 v[128:131], v46 offset:24576
    ds_read_b128 v[136:139], v46 offset:26624
    ds_read_b128 v[144:147], v46 offset:28672
    s_waitcnt lgkmcnt(2)
    v_pk_add_f32 v[224:225], v[224:225], v[128:129]
    v_pk_add_f32 v[226:227], v[226:227], v[130:131]
    s_waitcnt lgkmcnt(1)
    v_pk_add_f32 v[224:225], v[224:225], v[136:137]
    v_pk_add_f32 v[226:227], v[226:227], v[138:139]
    s_waitcnt lgkmcnt(0)
    v_pk_add_f32 v[224:225], v[224:225], v[144:145]
    v_pk_add_f32 v[226:227], v[226:227], v[146:147]
    v_cvt_pk_bf16_f32 v168, v224, v225
    v_cvt_pk_bf16_f32 v169, v226, v227
    v_cvt_pk_bf16_f32 v170, v228, v229
    v_cvt_pk_bf16_f32 v171, v230, v231
    buffer_store_dwordx4 v[168:171], v47, s[40:43], s100 offen offset:64 sc1
    s_endpgm
L_idle:
    s_add_u32 s58, s63, 0
    buffer_load_dword v132, v131, s[24:27], s58 offen
    s_waitcnt vmcnt(1)
    s_barrier
    s_cmp_lg_u32 s48, 0
    s_cbranch_scc1 L_noep_14
    s_mov_b64 exec, 0x3
    buffer_store_dword v51, v52, s[44:47], s96 offen sc1
    s_mov_b64 exec, -1
L_noep_14:
    s_barrier
    s_add_u32 s58, s63, 114688
    buffer_load_dword v132, v131, s[24:27], s58 offen
    s_add_u32 m0, s53, 0
    s_add_u32 s56, s98, 0
    buffer_load_dwordx4 v36, s[28:31], s56 offen offset:0 lds
    buffer_load_dwordx4 v37, s[28:31], s56 offen offset:1024 lds
    buffer_load_dwordx4 v38, s[28:31], s56 offen offset:2048 lds
    buffer_load_dwordx4 v39, s[28:31], s56 offen offset:3072 lds
    s_add_u32 m0, s53, 4096
    s_add_u32 s56, s98, 131072
    buffer_load_dwordx4 v36, s[28:31], s56 offen offset:0 lds
    buffer_load_dwordx4 v37, s[28:31], s56 offen offset:1024 lds
    buffer_load_dwordx4 v38, s[28:31], s56 offen offset:2048 lds
    buffer_load_dwordx4 v39, s[28:31], s56 offen offset:3072 lds
    s_add_u32 m0, s53, 8192
    s_add_u32 s56, s98, 262144
    buffer_load_dwordx4 v36, s[28:31], s56 offen offset:0 lds
    buffer_load_dwordx4 v37, s[28:31], s56 offen offset:1024 lds
    buffer_load_dwordx4 v38, s[28:31], s56 offen offset:2048 lds
    buffer_load_dwordx4 v39, s[28:31], s56 offen offset:3072 lds
    s_add_u32 m0, s53, 12288
    s_add_u32 s56, s98, 393216
    buffer_load_dwordx4 v36, s[28:31], s56 offen offset:0 lds
    buffer_load_dwordx4 v37, s[28:31], s56 offen offset:1024 lds
    buffer_load_dwordx4 v38, s[28:31], s56 offen offset:2048 lds
    buffer_load_dwordx4 v39, s[28:31], s56 offen offset:3072 lds
    s_add_u32 m0, s53, 16384
    s_add_u32 s56, s98, 524288
    buffer_load_dwordx4 v36, s[28:31], s56 offen offset:0 lds
    buffer_load_dwordx4 v37, s[28:31], s56 offen offset:1024 lds
    s_waitcnt vmcnt(14)
    ds_read_b64_tr_b16 a[0:1], v180 offset:0
    ds_read_b64_tr_b16 a[2:3], v180 offset:2048
    ds_read_b64_tr_b16 a[4:5], v181 offset:0
    ds_read_b64_tr_b16 a[6:7], v181 offset:2048
    ds_read_b64_tr_b16 a[8:9], v182 offset:0
    ds_read_b64_tr_b16 a[10:11], v182 offset:2048
    ds_read_b64_tr_b16 a[12:13], v183 offset:0
    ds_read_b64_tr_b16 a[14:15], v183 offset:2048
    buffer_load_dwordx4 v38, s[28:31], s56 offen offset:2048 lds
    buffer_load_dwordx4 v39, s[28:31], s56 offen offset:3072 lds
    s_add_u32 m0, s53, 20480
    s_add_u32 s56, s98, 655360
    buffer_load_dwordx4 v36, s[28:31], s56 offen offset:0 lds
    buffer_load_dwordx4 v37, s[28:31], s56 offen offset:1024 lds
    s_waitcnt vmcnt(14)
    ds_read_b64_tr_b16 a[16:17], v180 offset:4096
    ds_read_b64_tr_b16 a[18:19], v180 offset:6144
    ds_read_b64_tr_b16 a[20:21], v181 offset:4096
    ds_read_b64_tr_b16 a[22:23], v181 offset:6144
    ds_read_b64_tr_b16 a[24:25], v182 offset:4096
    ds_read_b64_tr_b16 a[26:27], v182 offset:6144
    ds_read_b64_tr_b16 a[28:29], v183 offset:4096
    ds_read_b64_tr_b16 a[30:31], v183 offset:6144
    buffer_load_dwordx4 v38, s[28:31], s56 offen offset:2048 lds
    buffer_load_dwordx4 v39, s[28:31], s56 offen offset:3072 lds
    s_add_u32 m0, s53, 24576
    s_add_u32 s56, s98, 786432
    buffer_load_dwordx4 v36, s[28:31], s56 offen offset:0 lds
    buffer_load_dwordx4 v37, s[28:31], s56 offen offset:1024 lds
    s_waitcnt vmcnt(14)
    ds_read_b64_tr_b16 a[32:33], v180 offset:8192
    ds_read_b64_tr_b16 a[34:35], v180 offset:10240
    ds_read_b64_tr_b16 a[36:37], v181 offset:8192
    ds_read_b64_tr_b16 a[38:39], v181 offset:10240
    ds_read_b64_tr_b16 a[40:41], v182 offset:8192
    ds_read_b64_tr_b16 a[42:43], v182 offset:10240
    ds_read_b64_tr_b16 a[44:45], v183 offset:8192
    ds_read_b64_tr_b16 a[46:47], v183 offset:10240
    buffer_load_dwordx4 v38, s[28:31], s56 offen offset:2048 lds
    buffer_load_dwordx4 v39, s[28:31], s56 offen offset:3072 lds
    s_waitcnt lgkmcnt(14)
    s_add_u32 m0, s53, 0
    s_add_u32 s56, s98, 917504
    buffer_load_dwordx4 v36, s[28:31], s56 offen offset:0 lds
    buffer_load_dwordx4 v37, s[28:31], s56 offen offset:1024 lds
    s_waitcnt vmcnt(14)
    ds_read_b64_tr_b16 a[48:49], v180 offset:12288
    ds_read_b64_tr_b16 a[50:51], v180 offset:14336
    ds_read_b64_tr_b16 a[52:53], v181 offset:12288
    ds_read_b64_tr_b16 a[54:55], v181 offset:14336
    ds_read_b64_tr_b16 a[56:57], v182 offset:12288
    ds_read_b64_tr_b16 a[58:59], v182 offset:14336
    ds_read_b64_tr_b16 a[60:61], v183 offset:12288
    ds_read_b64_tr_b16 a[62:63], v183 offset:14336
    buffer_load_dwordx4 v38, s[28:31], s56 offen offset:2048 lds
    buffer_load_dwordx4 v39, s[28:31], s56 offen offset:3072 lds
    s_waitcnt lgkmcnt(14)
    s_add_u32 m0, s53, 4096
    s_add_u32 s56, s98, 1048576
    buffer_load_dwordx4 v36, s[28:31], s56 offen offset:0 lds
    buffer_load_dwordx4 v37, s[28:31], s56 offen offset:1024 lds
    s_waitcnt vmcnt(14)
    ds_read_b64_tr_b16 a[64:65], v180 offset:16384
    ds_read_b64_tr_b16 a[66:67], v180 offset:18432
    ds_read_b64_tr_b16 a[68:69], v181 offset:16384
    ds_read_b64_tr_b16 a[70:71], v181 offset:18432
    ds_read_b64_tr_b16 a[72:73], v182 offset:16384
    ds_read_b64_tr_b16 a[74:75], v182 offset:18432
    ds_read_b64_tr_b16 a[76:77], v183 offset:16384
    ds_read_b64_tr_b16 a[78:79], v183 offset:18432
    buffer_load_dwordx4 v38, s[28:31], s56 offen offset:2048 lds
    buffer_load_dwordx4 v39, s[28:31], s56 offen offset:3072 lds
    s_waitcnt lgkmcnt(14)
    s_add_u32 m0, s53, 8192
    s_add_u32 s56, s98, 1179648
    buffer_load_dwordx4 v36, s[28:31], s56 offen offset:0 lds
    buffer_load_dwordx4 v37, s[28:31], s56 offen offset:1024 lds
    s_waitcnt vmcnt(14)
    ds_read_b64_tr_b16 a[80:81], v180 offset:20480
    ds_read_b64_tr_b16 a[82:83], v180 offset:22528
    ds_read_b64_tr_b16 a[84:85], v181 offset:20480
    ds_read_b64_tr_b16 a[86:87], v181 offset:22528
    ds_read_b64_tr_b16 a[88:89], v182 offset:20480
    ds_read_b64_tr_b16 a[90:91], v182 offset:22528
    ds_read_b64_tr_b16 a[92:93], v183 offset:20480
    ds_read_b64_tr_b16 a[94:95], v183 offset:22528
    buffer_load_dwordx4 v38, s[28:31], s56 offen offset:2048 lds
    buffer_load_dwordx4 v39, s[28:31], s56 offen offset:3072 lds
    s_waitcnt lgkmcnt(14)
    s_add_u32 m0, s53, 12288
    s_add_u32 s56, s98, 1310720
    buffer_load_dwordx4 v36, s[28:31], s56 offen offset:0 lds
    buffer_load_dwordx4 v37, s[28:31], s56 offen offset:1024 lds
    s_waitcnt vmcnt(14)
    ds_read_b64_tr_b16 a[96:97], v180 offset:24576
    ds_read_b64_tr_b16 a[98:99], v180 offset:26624
    ds_read_b64_tr_b16 a[100:101], v181 offset:24576
    ds_read_b64_tr_b16 a[102:103], v181 offset:26624
    ds_read_b64_tr_b16 a[104:105], v182 offset:24576
    ds_read_b64_tr_b16 a[106:107], v182 offset:26624
    ds_read_b64_tr_b16 a[108:109], v183 offset:24576
    ds_read_b64_tr_b16 a[110:111], v183 offset:26624
    buffer_load_dwordx4 v38, s[28:31], s56 offen offset:2048 lds
    buffer_load_dwordx4 v39, s[28:31], s56 offen offset:3072 lds
    s_waitcnt lgkmcnt(14)
    s_add_u32 m0, s53, 16384
    s_add_u32 s56, s98, 1441792
    buffer_load_dwordx4 v36, s[28:31], s56 offen offset:0 lds
    buffer_load_dwordx4 v37, s[28:31], s56 offen offset:1024 lds
    s_waitcnt vmcnt(14)
    ds_read_b64_tr_b16 a[112:113], v180 offset:0
    ds_read_b64_tr_b16 a[114:115], v180 offset:2048
    ds_read_b64_tr_b16 a[116:117], v181 offset:0
    ds_read_b64_tr_b16 a[118:119], v181 offset:2048
    ds_read_b64_tr_b16 a[120:121], v182 offset:0
    ds_read_b64_tr_b16 a[122:123], v182 offset:2048
    ds_read_b64_tr_b16 a[124:125], v183 offset:0
    ds_read_b64_tr_b16 a[126:127], v183 offset:2048
    buffer_load_dwordx4 v38, s[28:31], s56 offen offset:2048 lds
    buffer_load_dwordx4 v39, s[28:31], s56 offen offset:3072 lds
    s_waitcnt lgkmcnt(14)
    s_add_u32 m0, s53, 20480
    s_add_u32 s56, s98, 1572864
    buffer_load_dwordx4 v36, s[28:31], s56 offen offset:0 lds
    buffer_load_dwordx4 v37, s[28:31], s56 offen offset:1024 lds
    s_waitcnt vmcnt(14)
    ds_read_b64_tr_b16 a[128:129], v180 offset:4096
    ds_read_b64_tr_b16 a[130:131], v180 offset:6144
    ds_read_b64_tr_b16 a[132:133], v181 offset:4096
    ds_read_b64_tr_b16 a[134:135], v181 offset:6144
    ds_read_b64_tr_b16 a[136:137], v182 offset:4096
    ds_read_b64_tr_b16 a[138:139], v182 offset:6144
    ds_read_b64_tr_b16 a[140:141], v183 offset:4096
    ds_read_b64_tr_b16 a[142:143], v183 offset:6144
    buffer_load_dwordx4 v38, s[28:31], s56 offen offset:2048 lds
    buffer_load_dwordx4 v39, s[28:31], s56 offen offset:3072 lds
    s_waitcnt lgkmcnt(14)
    s_add_u32 m0, s53, 24576
    s_add_u32 s56, s98, 1703936
    buffer_load_dwordx4 v36, s[28:31], s56 offen offset:0 lds
    buffer_load_dwordx4 v37, s[28:31], s56 offen offset:1024 lds
    s_waitcnt vmcnt(14)
    ds_read_b64_tr_b16 a[144:145], v180 offset:8192
    ds_read_b64_tr_b16 a[146:147], v180 offset:10240
    ds_read_b64_tr_b16 a[148:149], v181 offset:8192
    ds_read_b64_tr_b16 a[150:151], v181 offset:10240
    ds_read_b64_tr_b16 a[152:153], v182 offset:8192
    ds_read_b64_tr_b16 a[154:155], v182 offset:10240
    ds_read_b64_tr_b16 a[156:157], v183 offset:8192
    ds_read_b64_tr_b16 a[158:159], v183 offset:10240
    buffer_load_dwordx4 v38, s[28:31], s56 offen offset:2048 lds
    buffer_load_dwordx4 v39, s[28:31], s56 offen offset:3072 lds
    s_lshr_b32 s57, s14, 7
    s_and_b32 s58, s51, 0x1c
    s_add_u32 s57, s57, s58
    s_sub_u32 s57, 3, s57
    s_and_b32 s57, s57, 7
    s_cmp_ge_u32 s57, 4
    s_cbranch_scc1 L_nohelp_15
    s_add_u32 s58, s58, s57
    s_sub_u32 s57, s51, s58
    s_and_b32 s57, s57, 3
    s_cmp_eq_u32 s57, 0
    s_cbranch_scc1 L_nohelp_15
    s_lshl_b32 s58, s58, 7
    s_mul_i32 s57, s57, 131072
    s_add_u32 s58, s58, s57
    s_mul_i32 s57, s48, 1835008
    s_add_u32 s58, s58, s57
    v_and_b32 v4, 31, v40
    v_lshlrev_b32 v4, 12, v4
    s_add_u32 s57, s58, 917504
    buffer_load_dword v8, v4, s[28:31], s57 offen
    s_add_u32 s57, s58, 1310720
    buffer_load_dword v8, v4, s[28:31], s57 offen
L_nohelp_15:
    v_mov_b32 v12, v50
    s_nop 1
    v_readfirstlane_b32 s57, v50
    s_nop 1
    v_mov_b32 v50, s57
    buffer_load_dword v48, v50, s[44:47], 0 offen sc1
    s_waitcnt vmcnt(0)
    v_cmp_ne_u32 vcc, s54, v48
    s_cbranch_vccz L_ok_16
    s_mov_b32 s59, 200000
L_spin_17:
    s_sleep 4
    buffer_load_dword v48, v50, s[44:47], 0 offen sc1
    s_sub_u32 s59, s59, 1
    s_cbranch_scc1 L_ok_16
    s_waitcnt vmcnt(0)
    v_cmp_ne_u32 vcc, s54, v48
    s_cbranch_vccnz L_spin_17
L_ok_16:
    v_mov_b32 v50, v12
    buffer_load_dword v48, v50, s[44:47], 0 offen sc1
    ds_read_b64_tr_b16 a[160:161], v180 offset:12288
    ds_read_b64_tr_b16 a[162:163], v180 offset:14336
    ds_read_b64_tr_b16 a[164:165], v181 offset:12288
    ds_read_b64_tr_b16 a[166:167], v181 offset:14336
    ds_read_b64_tr_b16 a[168:169], v182 offset:12288
    ds_read_b64_tr_b16 a[170:171], v182 offset:14336
    ds_read_b64_tr_b16 a[172:173], v183 offset:12288
    ds_read_b64_tr_b16 a[174:175], v183 offset:14336
    s_add_u32 s16, s99, 0
    s_add_u32 s17, s99, 4096
    s_add_u32 s18, s99, 8192
    s_add_u32 s19, s99, 12288
    v_add_u32 v184, 0x20000, v56
    v_add_u32 v185, 0x20000, v57
    v_lshlrev_b32 v160, 16, v53
    v_lshlrev_b32 v161, 16, v53
    v_lshlrev_b32 v162, 16, v53
    v_lshlrev_b32 v163, 16, v53
    s_waitcnt vmcnt(0)
    v_cmp_ne_u32 vcc, s54, v48
    s_cbranch_vccz L_ok_18
    s_mov_b32 s59, 200000
L_spin_19:
    s_sleep 4
    buffer_load_dword v48, v50, s[44:47], 0 offen sc1
    s_sub_u32 s59, s59, 1
    s_cbranch_scc1 L_ok_18
    s_waitcnt vmcnt(0)
    v_cmp_ne_u32 vcc, s54, v48
    s_cbranch_vccnz L_spin_19
L_ok_18:
    buffer_load_dwordx4 v[64:67], v56, s[36:39], s16 offen offset:0 sc1
    buffer_load_dwordx4 v[68:71], v56, s[36:39], s16 offen offset:1024 sc1
    buffer_load_dwordx4 v[72:75], v57, s[36:39], s16 offen offset:0 sc1
    buffer_load_dwordx4 v[76:79], v57, s[36:39], s16 offen offset:1024 sc1
    ds_read_b64_tr_b16 a[176:177], v180 offset:16384
    ds_read_b64_tr_b16 a[178:179], v180 offset:18432
    ds_read_b64_tr_b16 a[180:181], v181 offset:16384
    ds_read_b64_tr_b16 a[182:183], v181 offset:18432
    ds_read_b64_tr_b16 a[184:185], v182 offset:16384
    ds_read_b64_tr_b16 a[186:187], v182 offset:18432
    ds_read_b64_tr_b16 a[188:189], v183 offset:16384
    ds_read_b64_tr_b16 a[190:191], v183 offset:18432
    buffer_load_dwordx4 v[80:83], v56, s[36:39], s16 offen offset:2048 sc1
    buffer_load_dwordx4 v[84:87], v56, s[36:39], s16 offen offset:3072 sc1
    buffer_load_dwordx4 v[88:91], v57, s[36:39], s16 offen offset:2048 sc1
    buffer_load_dwordx4 v[92:95], v57, s[36:39], s16 offen offset:3072 sc1
    ds_read_b64_tr_b16 a[192:193], v180 offset:20480
    ds_read_b64_tr_b16 a[194:195], v180 offset:22528
    ds_read_b64_tr_b16 a[196:197], v181 offset:20480
    ds_read_b64_tr_b16 a[198:199], v181 offset:22528
    ds_read_b64_tr_b16 a[200:201], v182 offset:20480
    ds_read_b64_tr_b16 a[202:203], v182 offset:22528
    ds_read_b64_tr_b16 a[204:205], v183 offset:20480
    ds_read_b64_tr_b16 a[206:207], v183 offset:22528
    buffer_load_dwordx4 v[96:99], v56, s[36:39], s17 offen offset:0 sc1
    buffer_load_dwordx4 v[100:103], v56, s[36:39], s17 offen offset:1024 sc1
    buffer_load_dwordx4 v[104:107], v57, s[36:39], s17 offen offset:0 sc1
    buffer_load_dwordx4 v[108:111], v57, s[36:39], s17 offen offset:1024 sc1
    s_waitcnt vmcnt(11)
    v_mfma_f32_16x16x32_bf16 v[216:219], v[64:67], a[12:15], 0
    ds_read_b64_tr_b16 a[208:209], v180 offset:24576
    ds_read_b64_tr_b16 a[210:211], v180 offset:26624
    s_waitcnt vmcnt(10)
    v_mfma_f32_16x16x32_bf16 v[216:219], v[68:71], a[28:31], v[216:219]
    ds_read_b64_tr_b16 a[212:213], v181 offset:24576
    ds_read_b64_tr_b16 a[214:215], v181 offset:26624
    v_mfma_f32_16x16x32_bf16 v[208:211], v[64:67], a[8:11], 0
    ds_read_b64_tr_b16 a[216:217], v182 offset:24576
    ds_read_b64_tr_b16 a[218:219], v182 offset:26624
    v_mfma_f32_16x16x32_bf16 v[208:211], v[68:71], a[24:27], v[208:211]
    ds_read_b64_tr_b16 a[220:221], v183 offset:24576
    ds_read_b64_tr_b16 a[222:223], v183 offset:26624
    v_mfma_f32_16x16x32_bf16 v[200:203], v[64:67], a[4:7], 0
    buffer_load_dwordx4 v[112:115], v56, s[36:39], s17 offen offset:2048 sc1
    v_mfma_f32_16x16x32_bf16 v[200:203], v[68:71], a[20:23], v[200:203]
    v_mfma_f32_16x16x32_bf16 v[192:195], v[64:67], a[0:3], v[160:163]
    v_mfma_f32_16x16x32_bf16 v[192:195], v[68:71], a[16:19], v[192:195]
    buffer_load_dwordx4 v[116:119], v56, s[36:39], s17 offen offset:3072 sc1
    s_waitcnt vmcnt(11)
    v_mfma_f32_16x16x32_bf16 v[220:223], v[72:75], a[12:15], 0
    s_waitcnt vmcnt(10)
    v_mfma_f32_16x16x32_bf16 v[220:223], v[76:79], a[28:31], v[220:223]
    v_mfma_f32_16x16x32_bf16 v[212:215], v[72:75], a[8:11], 0
    v_mfma_f32_16x16x32_bf16 v[212:215], v[76:79], a[24:27], v[212:215]
    v_mfma_f32_16x16x32_bf16 v[204:207], v[72:75], a[4:7], 0
    buffer_load_dwordx4 v[120:123], v57, s[36:39], s17 offen offset:2048 sc1
    v_mfma_f32_16x16x32_bf16 v[204:207], v[76:79], a[20:23], v[204:207]
    v_mfma_f32_16x16x32_bf16 v[196:199], v[72:75], a[0:3], v[160:163]
    v_mfma_f32_16x16x32_bf16 v[196:199], v[76:79], a[16:19], v[196:199]
    buffer_load_dword v48, v50, s[44:47], s3 offen sc1
    s_waitcnt vmcnt(11)
    v_mfma_f32_16x16x32_bf16 v[216:219], v[80:83], a[44:47], v[216:219]
    s_waitcnt vmcnt(10)
    v_mfma_f32_16x16x32_bf16 v[216:219], v[84:87], a[60:63], v[216:219]
    v_mfma_f32_16x16x32_bf16 v[208:211], v[80:83], a[40:43], v[208:211]
    v_mfma_f32_16x16x32_bf16 v[208:211], v[84:87], a[56:59], v[208:211]
    v_mfma_f32_16x16x32_bf16 v[200:203], v[80:83], a[36:39], v[200:203]
    buffer_load_dwordx4 v[124:127], v57, s[36:39], s17 offen offset:3072 sc1
    v_mfma_f32_16x16x32_bf16 v[200:203], v[84:87], a[52:55], v[200:203]
    v_mfma_f32_16x16x32_bf16 v[192:195], v[80:83], a[32:35], v[192:195]
    v_mfma_f32_16x16x32_bf16 v[192:195], v[84:87], a[48:51], v[192:195]
    buffer_load_dwordx4 v[64:67], v56, s[36:39], s18 offen offset:0 sc1
    s_waitcnt vmcnt(11)
    v_mfma_f32_16x16x32_bf16 v[220:223], v[88:91], a[44:47], v[220:223]
    s_waitcnt vmcnt(10)
    v_mfma_f32_16x16x32_bf16 v[220:223], v[92:95], a[60:63], v[220:223]
    v_mfma_f32_16x16x32_bf16 v[212:215], v[88:91], a[40:43], v[212:215]
    v_mfma_f32_16x16x32_bf16 v[212:215], v[92:95], a[56:59], v[212:215]
    v_mfma_f32_16x16x32_bf16 v[204:207], v[88:91], a[36:39], v[204:207]
    buffer_load_dwordx4 v[68:71], v56, s[36:39], s18 offen offset:1024 sc1
    v_mfma_f32_16x16x32_bf16 v[204:207], v[92:95], a[52:55], v[204:207]
    v_mfma_f32_16x16x32_bf16 v[196:199], v[88:91], a[32:35], v[196:199]
    v_mfma_f32_16x16x32_bf16 v[196:199], v[92:95], a[48:51], v[196:199]
    buffer_load_dwordx4 v[72:75], v57, s[36:39], s18 offen offset:0 sc1
    s_waitcnt vmcnt(11)
    v_mfma_f32_16x16x32_bf16 v[216:219], v[96:99], a[76:79], v[216:219]
    s_waitcnt vmcnt(10)
    v_mfma_f32_16x16x32_bf16 v[216:219], v[100:103], a[92:95], v[216:219]
    v_mfma_f32_16x16x32_bf16 v[208:211], v[96:99], a[72:75], v[208:211]
    v_mfma_f32_16x16x32_bf16 v[208:211], v[100:103], a[88:91], v[208:211]
    v_mfma_f32_16x16x32_bf16 v[200:203], v[96:99], a[68:71], v[200:203]
    buffer_load_dwordx4 v[76:79], v57, s[36:39], s18 offen offset:1024 sc1
    v_mfma_f32_16x16x32_bf16 v[200:203], v[100:103], a[84:87], v[200:203]
    v_mfma_f32_16x16x32_bf16 v[192:195], v[96:99], a[64:67], v[192:195]
    v_mfma_f32_16x16x32_bf16 v[192:195], v[100:103], a[80:83], v[192:195]
    buffer_load_dwordx4 v[80:83], v56, s[36:39], s18 offen offset:2048 sc1
    s_waitcnt vmcnt(11)
    v_mfma_f32_16x16x32_bf16 v[220:223], v[104:107], a[76:79], v[220:223]
    s_waitcnt vmcnt(10)
    v_mfma_f32_16x16x32_bf16 v[220:223], v[108:111], a[92:95], v[220:223]
    v_mfma_f32_16x16x32_bf16 v[212:215], v[104:107], a[72:75], v[212:215]
    v_mfma_f32_16x16x32_bf16 v[212:215], v[108:111], a[88:91], v[212:215]
    v_mfma_f32_16x16x32_bf16 v[204:207], v[104:107], a[68:71], v[204:207]
    buffer_load_dwordx4 v[84:87], v56, s[36:39], s18 offen offset:3072 sc1
    v_mfma_f32_16x16x32_bf16 v[204:207], v[108:111], a[84:87], v[204:207]
    v_mfma_f32_16x16x32_bf16 v[196:199], v[104:107], a[64:67], v[196:199]
    v_mfma_f32_16x16x32_bf16 v[196:199], v[108:111], a[80:83], v[196:199]
    buffer_load_dwordx4 v[88:91], v57, s[36:39], s18 offen offset:2048 sc1
    s_waitcnt vmcnt(11) lgkmcnt(14)
    v_mfma_f32_16x16x32_bf16 v[216:219], v[112:115], a[108:111], v[216:219]
    s_waitcnt vmcnt(10)
    v_mfma_f32_16x16x32_bf16 v[216:219], v[116:119], a[124:127], v[216:219]
    v_mfma_f32_16x16x32_bf16 v[208:211], v[112:115], a[104:107], v[208:211]
    v_mfma_f32_16x16x32_bf16 v[208:211], v[116:119], a[120:123], v[208:211]
    v_mfma_f32_16x16x32_bf16 v[200:203], v[112:115], a[100:103], v[200:203]
    buffer_load_dwordx4 v[92:95], v57, s[36:39], s18 offen offset:3072 sc1
    v_mfma_f32_16x16x32_bf16 v[200:203], v[116:119], a[116:119], v[200:203]
    v_mfma_f32_16x16x32_bf16 v[192:195], v[112:115], a[96:99], v[192:195]
    v_mfma_f32_16x16x32_bf16 v[192:195], v[116:119], a[112:115], v[192:195]
    buffer_load_dwordx4 v[96:99], v56, s[36:39], s19 offen offset:0 sc1
    s_waitcnt vmcnt(11)
    v_mfma_f32_16x16x32_bf16 v[220:223], v[120:123], a[108:111], v[220:223]
    s_waitcnt vmcnt(9)
    v_mfma_f32_16x16x32_bf16 v[220:223], v[124:127], a[124:127], v[220:223]
    v_mfma_f32_16x16x32_bf16 v[212:215], v[120:123], a[104:107], v[212:215]
    v_mfma_f32_16x16x32_bf16 v[212:215], v[124:127], a[120:123], v[212:215]
    v_mfma_f32_16x16x32_bf16 v[204:207], v[120:123], a[100:103], v[204:207]
    buffer_load_dwordx4 v[100:103], v56, s[36:39], s19 offen offset:1024 sc1
    v_mfma_f32_16x16x32_bf16 v[204:207], v[124:127], a[116:119], v[204:207]
    v_mfma_f32_16x16x32_bf16 v[196:199], v[120:123], a[96:99], v[196:199]
    v_mfma_f32_16x16x32_bf16 v[196:199], v[124:127], a[112:115], v[196:199]
    buffer_load_dwordx4 v[104:107], v57, s[36:39], s19 offen offset:0 sc1
    buffer_load_dwordx4 v[108:111], v57, s[36:39], s19 offen offset:1024 sc1
    s_waitcnt vmcnt(11)
    v_mfma_f32_16x16x32_bf16 v[216:219], v[64:67], a[140:143], v[216:219]
    s_waitcnt vmcnt(10)
    v_mfma_f32_16x16x32_bf16 v[216:219], v[68:71], a[156:159], v[216:219]
    v_mfma_f32_16x16x32_bf16 v[208:211], v[64:67], a[136:139], v[208:211]
    v_mfma_f32_16x16x32_bf16 v[208:211], v[68:71], a[152:155], v[208:211]
    v_mfma_f32_16x16x32_bf16 v[200:203], v[64:67], a[132:135], v[200:203]
    v_cmp_ne_u32 vcc, s54, v48
    s_cbranch_vccz L_ok_20
    s_mov_b32 s59, 200000
L_spin_21:
    s_sleep 2
    buffer_load_dword v48, v50, s[44:47], s3 offen sc1
    s_sub_u32 s59, s59, 1
    s_cbranch_scc1 L_ok_20
    s_waitcnt vmcnt(0)
    v_cmp_ne_u32 vcc, s54, v48
    s_cbranch_vccnz L_spin_21
L_ok_20:
    buffer_load_dwordx4 v[112:115], v185, s[36:39], s16 offen offset:0 sc1
    v_mfma_f32_16x16x32_bf16 v[200:203], v[68:71], a[148:151], v[200:203]
    v_mfma_f32_16x16x32_bf16 v[192:195], v[64:67], a[128:131], v[192:195]
    v_mfma_f32_16x16x32_bf16 v[192:195], v[68:71], a[144:147], v[192:195]
    buffer_load_dwordx4 v[116:119], v185, s[36:39], s16 offen offset:1024 sc1
    s_waitcnt vmcnt(11)
    v_mfma_f32_16x16x32_bf16 v[220:223], v[72:75], a[140:143], v[220:223]
    s_waitcnt vmcnt(10)
    v_mfma_f32_16x16x32_bf16 v[220:223], v[76:79], a[156:159], v[220:223]
    v_mfma_f32_16x16x32_bf16 v[212:215], v[72:75], a[136:139], v[212:215]
    v_mfma_f32_16x16x32_bf16 v[212:215], v[76:79], a[152:155], v[212:215]
    v_mfma_f32_16x16x32_bf16 v[204:207], v[72:75], a[132:135], v[204:207]
    buffer_load_dwordx4 v[120:123], v185, s[36:39], s16 offen offset:2048 sc1
    v_mfma_f32_16x16x32_bf16 v[204:207], v[76:79], a[148:151], v[204:207]
    v_mfma_f32_16x16x32_bf16 v[196:199], v[72:75], a[128:131], v[196:199]
    v_mfma_f32_16x16x32_bf16 v[196:199], v[76:79], a[144:147], v[196:199]
    buffer_load_dwordx4 v[124:127], v185, s[36:39], s16 offen offset:3072 sc1
    s_waitcnt vmcnt(11)
    v_mfma_f32_16x16x32_bf16 v[216:219], v[80:83], a[172:175], v[216:219]
    s_waitcnt vmcnt(10)
    v_mfma_f32_16x16x32_bf16 v[216:219], v[84:87], a[188:191], v[216:219]
    v_mfma_f32_16x16x32_bf16 v[208:211], v[80:83], a[168:171], v[208:211]
    v_mfma_f32_16x16x32_bf16 v[208:211], v[84:87], a[184:187], v[208:211]
    v_mfma_f32_16x16x32_bf16 v[200:203], v[80:83], a[164:167], v[200:203]
    buffer_load_dwordx4 v[64:67], v185, s[36:39], s17 offen offset:0 sc1
    v_mfma_f32_16x16x32_bf16 v[200:203], v[84:87], a[180:183], v[200:203]
    v_mfma_f32_16x16x32_bf16 v[192:195], v[80:83], a[160:163], v[192:195]
    v_mfma_f32_16x16x32_bf16 v[192:195], v[84:87], a[176:179], v[192:195]
    buffer_load_dwordx4 v[68:71], v185, s[36:39], s17 offen offset:1024 sc1
    s_waitcnt vmcnt(11)
    v_mfma_f32_16x16x32_bf16 v[220:223], v[88:91], a[172:175], v[220:223]
    s_waitcnt vmcnt(10)
    v_mfma_f32_16x16x32_bf16 v[220:223], v[92:95], a[188:191], v[220:223]
    v_mfma_f32_16x16x32_bf16 v[212:215], v[88:91], a[168:171], v[212:215]
    v_mfma_f32_16x16x32_bf16 v[212:215], v[92:95], a[184:187], v[212:215]
    v_mfma_f32_16x16x32_bf16 v[204:207], v[88:91], a[164:167], v[204:207]
    buffer_load_dwordx4 v[72:75], v185, s[36:39], s17 offen offset:2048 sc1
    v_mfma_f32_16x16x32_bf16 v[204:207], v[92:95], a[180:183], v[204:207]
    v_mfma_f32_16x16x32_bf16 v[196:199], v[88:91], a[160:163], v[196:199]
    v_mfma_f32_16x16x32_bf16 v[196:199], v[92:95], a[176:179], v[196:199]
    buffer_load_dwordx4 v[76:79], v185, s[36:39], s17 offen offset:3072 sc1
    s_waitcnt vmcnt(11) lgkmcnt(0)
    v_mfma_f32_16x16x32_bf16 v[216:219], v[96:99], a[204:207], v[216:219]
    s_waitcnt vmcnt(10)
    v_mfma_f32_16x16x32_bf16 v[216:219], v[100:103], a[220:223], v[216:219]
    v_mfma_f32_16x16x32_bf16 v[208:211], v[96:99], a[200:203], v[208:211]
    v_mfma_f32_16x16x32_bf16 v[208:211], v[100:103], a[216:219], v[208:211]
    v_mfma_f32_16x16x32_bf16 v[200:203], v[96:99], a[196:199], v[200:203]
    buffer_load_dwordx4 v[80:83], v185, s[36:39], s18 offen offset:0 sc1
    v_mfma_f32_16x16x32_bf16 v[200:203], v[100:103], a[212:215], v[200:203]
    v_mfma_f32_16x16x32_bf16 v[192:195], v[96:99], a[192:195], v[192:195]
    v_mfma_f32_16x16x32_bf16 v[192:195], v[100:103], a[208:211], v[192:195]
    buffer_load_dwordx4 v[84:87], v185, s[36:39], s18 offen offset:1024 sc1
    s_waitcnt vmcnt(11)
    v_mfma_f32_16x16x32_bf16 v[220:223], v[104:107], a[204:207], v[220:223]
    s_waitcnt vmcnt(10)
    v_mfma_f32_16x16x32_bf16 v[220:223], v[108:111], a[220:223], v[220:223]
    v_mfma_f32_16x16x32_bf16 v[212:215], v[104:107], a[200:203], v[212:215]
    v_mfma_f32_16x16x32_bf16 v[212:215], v[108:111], a[216:219], v[212:215]
    v_mfma_f32_16x16x32_bf16 v[204:207], v[104:107], a[196:199], v[204:207]
    buffer_load_dwordx4 v[88:91], v185, s[36:39], s18 offen offset:2048 sc1
    v_mfma_f32_16x16x32_bf16 v[204:207], v[108:111], a[212:215], v[204:207]
    v_mfma_f32_16x16x32_bf16 v[196:199], v[104:107], a[192:195], v[196:199]
    v_mfma_f32_16x16x32_bf16 v[196:199], v[108:111], a[208:211], v[196:199]
    buffer_load_dwordx4 v[92:95], v185, s[36:39], s18 offen offset:3072 sc1
    s_waitcnt vmcnt(11)
    v_mfma_f32_16x16x32_bf16 v[252:255], v[112:115], a[12:15], 0
    s_waitcnt vmcnt(10)
    v_mfma_f32_16x16x32_bf16 v[252:255], v[116:119], a[28:31], v[252:255]
    v_mfma_f32_16x16x32_bf16 v[244:247], v[112:115], a[8:11], 0
    v_mfma_f32_16x16x32_bf16 v[244:247], v[116:119], a[24:27], v[244:247]
    v_mfma_f32_16x16x32_bf16 v[236:239], v[112:115], a[4:7], 0
    buffer_load_dwordx4 v[96:99], v185, s[36:39], s19 offen offset:0 sc1
    v_mfma_f32_16x16x32_bf16 v[236:239], v[116:119], a[20:23], v[236:239]
    ds_write_b128 v45, v[216:219] offset:0
    v_mfma_f32_16x16x32_bf16 v[228:231], v[112:115], a[0:3], v[160:163]
    v_mfma_f32_16x16x32_bf16 v[228:231], v[116:119], a[16:19], v[228:231]
    buffer_load_dwordx4 v[100:103], v185, s[36:39], s19 offen offset:1024 sc1
    s_waitcnt vmcnt(11)
    v_mfma_f32_16x16x32_bf16 v[252:255], v[120:123], a[44:47], v[252:255]
    ds_write_b128 v45, v[220:223] offset:1024
    s_waitcnt vmcnt(10)
    v_mfma_f32_16x16x32_bf16 v[252:255], v[124:127], a[60:63], v[252:255]
    v_mfma_f32_16x16x32_bf16 v[244:247], v[120:123], a[40:43], v[244:247]
    v_mfma_f32_16x16x32_bf16 v[244:247], v[124:127], a[56:59], v[244:247]
    v_mfma_f32_16x16x32_bf16 v[236:239], v[120:123], a[36:39], v[236:239]
    buffer_load_dwordx4 v[104:107], v184, s[36:39], s16 offen offset:0 sc1
    v_mfma_f32_16x16x32_bf16 v[236:239], v[124:127], a[52:55], v[236:239]
    ds_write_b128 v44, v[208:211] offset:0
    v_mfma_f32_16x16x32_bf16 v[228:231], v[120:123], a[32:35], v[228:231]
    v_mfma_f32_16x16x32_bf16 v[228:231], v[124:127], a[48:51], v[228:231]
    buffer_load_dwordx4 v[108:111], v184, s[36:39], s16 offen offset:1024 sc1
    s_waitcnt vmcnt(11)
    v_mfma_f32_16x16x32_bf16 v[252:255], v[64:67], a[76:79], v[252:255]
    ds_write_b128 v44, v[212:215] offset:1024
    s_waitcnt vmcnt(10)
    v_mfma_f32_16x16x32_bf16 v[252:255], v[68:71], a[92:95], v[252:255]
    v_mfma_f32_16x16x32_bf16 v[244:247], v[64:67], a[72:75], v[244:247]
    v_mfma_f32_16x16x32_bf16 v[244:247], v[68:71], a[88:91], v[244:247]
    v_mfma_f32_16x16x32_bf16 v[236:239], v[64:67], a[68:71], v[236:239]
    buffer_load_dwordx4 v[112:115], v184, s[36:39], s16 offen offset:2048 sc1
    v_mfma_f32_16x16x32_bf16 v[236:239], v[68:71], a[84:87], v[236:239]
    ds_write_b128 v43, v[200:203] offset:0
    v_mfma_f32_16x16x32_bf16 v[228:231], v[64:67], a[64:67], v[228:231]
    v_mfma_f32_16x16x32_bf16 v[228:231], v[68:71], a[80:83], v[228:231]
    buffer_load_dwordx4 v[116:119], v184, s[36:39], s16 offen offset:3072 sc1
    s_waitcnt vmcnt(11)
    v_mfma_f32_16x16x32_bf16 v[252:255], v[72:75], a[108:111], v[252:255]
    ds_write_b128 v43, v[204:207] offset:1024
    s_waitcnt vmcnt(10)
    v_mfma_f32_16x16x32_bf16 v[252:255], v[76:79], a[124:127], v[252:255]
    v_mfma_f32_16x16x32_bf16 v[244:247], v[72:75], a[104:107], v[244:247]
    v_mfma_f32_16x16x32_bf16 v[244:247], v[76:79], a[120:123], v[244:247]
    v_mfma_f32_16x16x32_bf16 v[236:239], v[72:75], a[100:103], v[236:239]
    buffer_load_dwordx4 v[120:123], v184, s[36:39], s17 offen offset:0 sc1
    v_mfma_f32_16x16x32_bf16 v[236:239], v[76:79], a[116:119], v[236:239]
    v_mfma_f32_16x16x32_bf16 v[228:231], v[72:75], a[96:99], v[228:231]
    v_mfma_f32_16x16x32_bf16 v[228:231], v[76:79], a[112:115], v[228:231]
    buffer_load_dwordx4 v[124:127], v184, s[36:39], s17 offen offset:1024 sc1
    s_waitcnt vmcnt(11)
    v_mfma_f32_16x16x32_bf16 v[252:255], v[80:83], a[140:143], v[252:255]
    s_waitcnt lgkmcnt(0)
    s_barrier
    s_waitcnt vmcnt(10)
    v_mfma_f32_16x16x32_bf16 v[252:255], v[84:87], a[156:159], v[252:255]
    ds_read_b128 v[128:131], v46 offset:0
    ds_read_b128 v[132:135], v46 offset:1024
    v_mfma_f32_16x16x32_bf16 v[244:247], v[80:83], a[136:139], v[244:247]
    ds_read_b128 v[136:139], v46 offset:2048
    ds_read_b128 v[140:143], v46 offset:3072
    v_mfma_f32_16x16x32_bf16 v[244:247], v[84:87], a[152:155], v[244:247]
    ds_read_b128 v[144:147], v46 offset:4096
    ds_read_b128 v[148:151], v46 offset:5120
    v_mfma_f32_16x16x32_bf16 v[236:239], v[80:83], a[132:135], v[236:239]
    buffer_load_dwordx4 v[64:67], v184, s[36:39], s17 offen offset:2048 sc1
    v_mfma_f32_16x16x32_bf16 v[236:239], v[84:87], a[148:151], v[236:239]
    v_mfma_f32_16x16x32_bf16 v[228:231], v[80:83], a[128:131], v[228:231]
    v_mfma_f32_16x16x32_bf16 v[228:231], v[84:87], a[144:147], v[228:231]
    buffer_load_dwordx4 v[68:71], v184, s[36:39], s17 offen offset:3072 sc1
    s_waitcnt vmcnt(11)
    v_mfma_f32_16x16x32_bf16 v[252:255], v[88:91], a[172:175], v[252:255]
    s_waitcnt lgkmcnt(4)
    v_add_f32 v192, v192, v128
    v_add_f32 v193, v193, v129
    s_waitcnt vmcnt(10)
    v_mfma_f32_16x16x32_bf16 v[252:255], v[92:95], a[188:191], v[252:255]
    v_add_f32 v194, v194, v130
    v_add_f32 v195, v195, v131
    v_mfma_f32_16x16x32_bf16 v[244:247], v[88:91], a[168:171], v[244:247]
    v_add_f32 v196, v196, v132
    v_add_f32 v197, v197, v133
    v_mfma_f32_16x16x32_bf16 v[244:247], v[92:95], a[184:187], v[244:247]
    v_add_f32 v198, v198, v134
    v_add_f32 v199, v199, v135
    v_mfma_f32_16x16x32_bf16 v[236:239], v[88:91], a[164:167], v[236:239]
    buffer_load_dwordx4 v[72:75], v184, s[36:39], s18 offen offset:0 sc1
    v_mfma_f32_16x16x32_bf16 v[236:239], v[92:95], a[180:183], v[236:239]
    s_waitcnt lgkmcnt(2)
    v_add_f32 v192, v192, v136
    v_add_f32 v193, v193, v137
    v_mfma_f32_16x16x32_bf16 v[228:231], v[88:91], a[160:163], v[228:231]
    v_add_f32 v194, v194, v138
    v_add_f32 v195, v195, v139
    v_mfma_f32_16x16x32_bf16 v[228:231], v[92:95], a[176:179], v[228:231]
    buffer_load_dwordx4 v[76:79], v184, s[36:39], s18 offen offset:1024 sc1
    s_waitcnt vmcnt(11)
    v_mfma_f32_16x16x32_bf16 v[252:255], v[96:99], a[204:207], v[252:255]
    v_add_f32 v196, v196, v140
    v_add_f32 v197, v197, v141
    s_waitcnt vmcnt(10)
    v_mfma_f32_16x16x32_bf16 v[252:255], v[100:103], a[220:223], v[252:255]
    v_add_f32 v198, v198, v142
    v_add_f32 v199, v199, v143
    v_mfma_f32_16x16x32_bf16 v[244:247], v[96:99], a[200:203], v[244:247]
    s_waitcnt lgkmcnt(0)
    v_add_f32 v192, v192, v144
    v_add_f32 v193, v193, v145
    v_mfma_f32_16x16x32_bf16 v[244:247], v[100:103], a[216:219], v[244:247]
    v_add_f32 v194, v194, v146
    v_add_f32 v195, v195, v147
    v_mfma_f32_16x16x32_bf16 v[236:239], v[96:99], a[196:199], v[236:239]
    buffer_load_dwordx4 v[80:83], v184, s[36:39], s18 offen offset:2048 sc1
    v_mfma_f32_16x16x32_bf16 v[236:239], v[100:103], a[212:215], v[236:239]
    v_add_f32 v196, v196, v148
    v_add_f32 v197, v197, v149
    v_mfma_f32_16x16x32_bf16 v[228:231], v[96:99], a[192:195], v[228:231]
    v_add_f32 v198, v198, v150
    v_add_f32 v199, v199, v151
    v_mfma_f32_16x16x32_bf16 v[228:231], v[100:103], a[208:211], v[228:231]
    buffer_load_dwordx4 v[84:87], v184, s[36:39], s18 offen offset:3072 sc1
    s_waitcnt vmcnt(11)
    v_mfma_f32_16x16x32_bf16 v[248:251], v[104:107], a[12:15], 0
    v_cvt_pk_bf16_f32 v164, v192, v193
    v_cvt_pk_bf16_f32 v165, v194, v195
    s_waitcnt vmcnt(10)
    v_mfma_f32_16x16x32_bf16 v[248:251], v[108:111], a[28:31], v[248:251]
    v_cvt_pk_bf16_f32 v166, v196, v197
    v_cvt_pk_bf16_f32 v167, v198, v199
    v_mfma_f32_16x16x32_bf16 v[240:243], v[104:107], a[8:11], 0
    v_mfma_f32_16x16x32_bf16 v[240:243], v[108:111], a[24:27], v[240:243]
    v_mfma_f32_16x16x32_bf16 v[232:235], v[104:107], a[4:7], 0
    buffer_load_dwordx4 v[88:91], v184, s[36:39], s19 offen offset:0 sc1
    v_mfma_f32_16x16x32_bf16 v[232:235], v[108:111], a[20:23], v[232:235]
    ds_write_b128 v45, v[252:255] offset:25600
    v_mfma_f32_16x16x32_bf16 v[224:227], v[104:107], a[0:3], v[160:163]
    v_mfma_f32_16x16x32_bf16 v[224:227], v[108:111], a[16:19], v[224:227]
    buffer_load_dwordx4 v[92:95], v184, s[36:39], s19 offen offset:1024 sc1
    s_waitcnt vmcnt(11)
    v_mfma_f32_16x16x32_bf16 v[248:251], v[112:115], a[44:47], v[248:251]
    s_waitcnt vmcnt(10)
    v_mfma_f32_16x16x32_bf16 v[248:251], v[116:119], a[60:63], v[248:251]
    ds_write_b128 v44, v[244:247] offset:25600
    v_mfma_f32_16x16x32_bf16 v[240:243], v[112:115], a[40:43], v[240:243]
    v_mfma_f32_16x16x32_bf16 v[240:243], v[116:119], a[56:59], v[240:243]
    v_mfma_f32_16x16x32_bf16 v[232:235], v[112:115], a[36:39], v[232:235]
    v_mfma_f32_16x16x32_bf16 v[232:235], v[116:119], a[52:55], v[232:235]
    ds_write_b128 v43, v[236:239] offset:25600
    v_mfma_f32_16x16x32_bf16 v[224:227], v[112:115], a[32:35], v[224:227]
    v_mfma_f32_16x16x32_bf16 v[224:227], v[116:119], a[48:51], v[224:227]
    s_waitcnt vmcnt(9)
    v_mfma_f32_16x16x32_bf16 v[248:251], v[120:123], a[76:79], v[248:251]
    s_waitcnt vmcnt(8)
    v_mfma_f32_16x16x32_bf16 v[248:251], v[124:127], a[92:95], v[248:251]
    v_mfma_f32_16x16x32_bf16 v[240:243], v[120:123], a[72:75], v[240:243]
    v_mfma_f32_16x16x32_bf16 v[240:243], v[124:127], a[88:91], v[240:243]
    v_mfma_f32_16x16x32_bf16 v[232:235], v[120:123], a[68:71], v[232:235]
    v_mfma_f32_16x16x32_bf16 v[232:235], v[124:127], a[84:87], v[232:235]
    s_waitcnt lgkmcnt(0)
    s_barrier
    v_mfma_f32_16x16x32_bf16 v[224:227], v[120:123], a[64:67], v[224:227]
    ds_read_b128 v[132:135], v46 offset:25600
    ds_read_b128 v[140:143], v46 offset:27648
    v_mfma_f32_16x16x32_bf16 v[224:227], v[124:127], a[80:83], v[224:227]
    s_waitcnt vmcnt(7)
    v_mfma_f32_16x16x32_bf16 v[248:251], v[64:67], a[108:111], v[248:251]
    ds_read_b128 v[148:151], v46 offset:29696
    s_waitcnt vmcnt(6)
    v_mfma_f32_16x16x32_bf16 v[248:251], v[68:71], a[124:127], v[248:251]
    v_mfma_f32_16x16x32_bf16 v[240:243], v[64:67], a[104:107], v[240:243]
    v_mfma_f32_16x16x32_bf16 v[240:243], v[68:71], a[120:123], v[240:243]
    v_mfma_f32_16x16x32_bf16 v[232:235], v[64:67], a[100:103], v[232:235]
    v_mfma_f32_16x16x32_bf16 v[232:235], v[68:71], a[116:119], v[232:235]
    v_mfma_f32_16x16x32_bf16 v[224:227], v[64:67], a[96:99], v[224:227]
    v_mfma_f32_16x16x32_bf16 v[224:227], v[68:71], a[112:115], v[224:227]
    s_waitcnt vmcnt(5)
    v_mfma_f32_16x16x32_bf16 v[248:251], v[72:75], a[140:143], v[248:251]
    s_waitcnt lgkmcnt(0)
    v_add_f32 v228, v228, v132
    v_add_f32 v229, v229, v133
    s_waitcnt vmcnt(4)
    v_mfma_f32_16x16x32_bf16 v[248:251], v[76:79], a[156:159], v[248:251]
    v_add_f32 v230, v230, v134
    v_add_f32 v231, v231, v135
    v_mfma_f32_16x16x32_bf16 v[240:243], v[72:75], a[136:139], v[240:243]
    v_add_f32 v228, v228, v140
    v_add_f32 v229, v229, v141
    v_mfma_f32_16x16x32_bf16 v[240:243], v[76:79], a[152:155], v[240:243]
    v_add_f32 v230, v230, v142
    v_add_f32 v231, v231, v143
    v_mfma_f32_16x16x32_bf16 v[232:235], v[72:75], a[132:135], v[232:235]
    v_mfma_f32_16x16x32_bf16 v[232:235], v[76:79], a[148:151], v[232:235]
    v_add_f32 v228, v228, v148
    v_add_f32 v229, v229, v149
    v_mfma_f32_16x16x32_bf16 v[224:227], v[72:75], a[128:131], v[224:227]
    v_add_f32 v230, v230, v150
    v_add_f32 v231, v231, v151
    v_mfma_f32_16x16x32_bf16 v[224:227], v[76:79], a[144:147], v[224:227]
    s_waitcnt vmcnt(3)
    v_mfma_f32_16x16x32_bf16 v[248:251], v[80:83], a[172:175], v[248:251]
    buffer_store_dwordx4 v[164:167], v47, s[40:43], s100 offen offset:0 sc1
    s_waitcnt vmcnt(3)
    v_mfma_f32_16x16x32_bf16 v[248:251], v[84:87], a[188:191], v[248:251]
    v_mfma_f32_16x16x32_bf16 v[240:243], v[80:83], a[168:171], v[240:243]
    v_mfma_f32_16x16x32_bf16 v[240:243], v[84:87], a[184:187], v[240:243]
    v_mfma_f32_16x16x32_bf16 v[232:235], v[80:83], a[164:167], v[232:235]
    v_mfma_f32_16x16x32_bf16 v[232:235], v[84:87], a[180:183], v[232:235]
    v_mfma_f32_16x16x32_bf16 v[224:227], v[80:83], a[160:163], v[224:227]
    v_mfma_f32_16x16x32_bf16 v[224:227], v[84:87], a[176:179], v[224:227]
    s_waitcnt vmcnt(2)
    v_mfma_f32_16x16x32_bf16 v[248:251], v[88:91], a[204:207], v[248:251]
    v_mfma_f32_16x16x32_bf16 v[240:243], v[88:91], a[200:203], v[240:243]
    v_mfma_f32_16x16x32_bf16 v[232:235], v[88:91], a[196:199], v[232:235]
    v_mfma_f32_16x16x32_bf16 v[224:227], v[88:91], a[192:195], v[224:227]
    s_waitcnt vmcnt(1)
    v_mfma_f32_16x16x32_bf16 v[248:251], v[92:95], a[220:223], v[248:251]
    v_mfma_f32_16x16x32_bf16 v[240:243], v[92:95], a[216:219], v[240:243]
    v_mfma_f32_16x16x32_bf16 v[232:235], v[92:95], a[212:215], v[232:235]
    v_mfma_f32_16x16x32_bf16 v[224:227], v[92:95], a[208:211], v[224:227]
    s_nop 7
    ds_write_b128 v45, v[248:251] offset:24576
    ds_write_b128 v44, v[240:243] offset:24576
    ds_write_b128 v43, v[232:235] offset:24576
    s_waitcnt lgkmcnt(0)
    s_barrier
    ds_read_b128 v[128:131], v46 offset:24576
    ds_read_b128 v[136:139], v46 offset:26624
    ds_read_b128 v[144:147], v46 offset:28672
    s_waitcnt lgkmcnt(2)
    v_pk_add_f32 v[224:225], v[224:225], v[128:129]
    v_pk_add_f32 v[226:227], v[226:227], v[130:131]
    s_waitcnt lgkmcnt(1)
    v_pk_add_f32 v[224:225], v[224:225], v[136:137]
    v_pk_add_f32 v[226:227], v[226:227], v[138:139]
    s_waitcnt lgkmcnt(0)
    v_pk_add_f32 v[224:225], v[224:225], v[144:145]
    v_pk_add_f32 v[226:227], v[226:227], v[146:147]
    v_cvt_pk_bf16_f32 v168, v224, v225
    v_cvt_pk_bf16_f32 v169, v226, v227
    v_cvt_pk_bf16_f32 v170, v228, v229
    v_cvt_pk_bf16_f32 v171, v230, v231
    buffer_store_dwordx4 v[168:171], v47, s[40:43], s100 offen offset:64 sc1
    s_endpgm
L_end:
    s_endpgm
.section .rodata,"a"
.p2align 6
.amdhsa_kernel standalone__mixer_token_mlp__prompt_kernel
  .amdhsa_next_free_vgpr 512
  .amdhsa_next_free_sgpr 102
  .amdhsa_accum_offset 256
  .amdhsa_group_segment_fixed_size 0
  .amdhsa_kernarg_size 64
  .amdhsa_user_sgpr_count 2
  .amdhsa_user_sgpr_kernarg_segment_ptr 1
  .amdhsa_system_sgpr_workgroup_id_x 1
.end_amdhsa_kernel
```
